```python
import torch

def _softmax(x, axis=-1):
    return torch.softmax(x, dim=axis)
def _gelu(x):
    return torch.nn.functional.gelu(x, approximate="tanh")
def _silu(x):
    return torch.nn.functional.silu(x)
def _sigmoid(x):
    return torch.sigmoid(x)
def _layernorm(x, axis=-1, eps=1e-5):
    m = x.mean(dim=axis, keepdim=True)
    v = x.var(dim=axis, keepdim=True, unbiased=False)
    return (x - m) / torch.sqrt(v + eps)
def _scatter_add(tgt, idx, src, axis=0):
    return tgt.clone().index_add_(axis, idx, src)
def _segment_sum(src, seg, n):
    out = torch.zeros((n,) + src.shape[1:], dtype=src.dtype)
    return out.index_add_(0, seg, src)
def _pad(x, pw):
    flat = tuple(v for pair in reversed(pw) for v in pair)
    return torch.nn.functional.pad(x, flat)

kernel_name = 'recurrent_scan__ssm_conv_s4__moe_arch_mod__prompt'

def setup_inputs():

    _w = (lambda a: (lambda t: t.to(torch.bfloat16) if t.is_floating_point() else t)(torch.as_tensor(a)))
    def _A_setup():
        B, L, D, N = 1, 2048, 448, 256
        A_re = -(lambda _x: torch.exp(torch.as_tensor(_x)))((lambda *s: torch.randn(*s, dtype=torch.bfloat16) * 6.4)(D, N))
        A_im = torch.pi * (lambda *s: torch.randn(*s, dtype=torch.bfloat16) * 0.05)(D, N)
        B_re = (lambda *s: torch.randn(*s, dtype=torch.bfloat16) * 0.1)(D, N)
        B_im = (lambda *s: torch.randn(*s, dtype=torch.bfloat16) * 0.1)(D, N)
        C_re = (lambda *s: torch.randn(*s, dtype=torch.bfloat16) * 0.1)(D, N)
        C_im = (lambda *s: torch.randn(*s, dtype=torch.bfloat16) * 0.1)(D, N)
        log_dt = (lambda *s: torch.randn(*s, dtype=torch.bfloat16) * 0.05)(D) * 0.5 - 4.0
        Dskip = (lambda *s: torch.randn(*s, dtype=torch.bfloat16) * 0.05)(D)
        return {
            "u": _w((lambda *s: torch.randn(*s, dtype=torch.bfloat16) * 0.05)(B, L, D)),
            "A_re": _w(A_re),
            "A_im": _w(A_im),
            "B_re": _w(B_re),
            "B_im": _w(B_im),
            "C_re": _w(C_re),
            "C_im": _w(C_im),
            "log_dt": _w(log_dt),
            "Dskip": _w(Dskip),
        }
    _A_in = _A_setup()

    def _B_setup():
        B, S, D, F, C = 1, 2048, 448, 1792, 1
        return {
            "x": _w((lambda *s: torch.randn(*s, dtype=torch.bfloat16) * 0.05)(B, S, D)),
            "w_r": _w((lambda *s: torch.randn(*s, dtype=torch.bfloat16) * 6.4)(D)),
            "w_gate": _w((lambda *s: torch.randn(*s, dtype=torch.bfloat16) * 0.1)(D, F)),
            "w_up": _w((lambda *s: torch.randn(*s, dtype=torch.bfloat16) * 0.1)(D, F)),
            "w_down": _w((lambda *s: torch.randn(*s, dtype=torch.bfloat16) * 0.1)(F, D)),
        }
    _B_in = _B_setup()

    return {
        "A_u": _A_in["u"],
        "A_A_re": _A_in["A_re"],
        "A_A_im": _A_in["A_im"],
        "A_B_re": _A_in["B_re"],
        "A_B_im": _A_in["B_im"],
        "A_C_re": _A_in["C_re"],
        "A_C_im": _A_in["C_im"],
        "A_log_dt": _A_in["log_dt"],
        "A_Dskip": _A_in["Dskip"],
        "B_x": _B_in["x"],
        "B_w_r": _B_in["w_r"],
        "B_w_gate": _B_in["w_gate"],
        "B_w_up": _B_in["w_up"],
        "B_w_down": _B_in["w_down"],
    }

def reference(A_u, A_A_re, A_A_im, A_B_re, A_B_im, A_C_re, A_C_im, A_log_dt, A_Dskip, B_x, B_w_r, B_w_gate, B_w_up, B_w_down):
    def _A_ref(u, A_re, A_im, B_re, B_im, C_re, C_im, log_dt, Dskip):
        Bsz, L, D = u.shape
        dt = torch.exp(log_dt)[:, None]
        A = A_re + 1j * A_im
        Bc = B_re + 1j * B_im
        Cc = C_re + 1j * C_im
        logdA = dt * A
        dB = dt * Bc
        l = (lambda x, dt: x.to(dt))(torch.arange(L), A_re.dtype)
        P = torch.exp(logdA[:, :, None] * l[None, None, :])
        K = torch.einsum("dn,dnl,dn->dl", Cc, P, dB).real
        L2 = 2 * L
        Kp = _pad(K, ((0, 0), (0, L)))
        up = (lambda x, *d: x.permute(*d))(u, 0, 2, 1)
        up = _pad(up, ((0, 0), (0, 0), (0, L)))
        Kf = (lambda x, axes=(-2,-1): torch.fft.rfft2(x.float(), dim=axes))(Kp[:, None, :], axes=(-2, -1))
        Uf = (lambda x, axes=(-2,-1): torch.fft.rfft2(x.float(), dim=axes))(up[:, :, None, :], axes=(-2, -1))
        Yf = Uf * Kf[None, :, :, :]
        y = (lambda x, s, axes=(-2,-1): torch.fft.irfft2(x, s=s, dim=axes).to(torch.bfloat16))(Yf, (1, L2), axes=(-2, -1))[:, :, 0, :L]
        y = (lambda x, *d: x.permute(*d))(y, 0, 2, 1) + u * Dskip[None, None, :]
        return y

    def _B_ref(x, w_r, w_gate, w_up, w_down):
        B, S, D = x.shape
        C = 1
        r = x @ w_r
        idx = torch.argsort(-r, axis=-1)[:, :C]
        idx_e = (lambda x, n, axis: torch.repeat_interleave(x, n, dim=axis))(idx.reshape(B, C, 1), D, axis=2)
        x_sel = (lambda x, i, axis: torch.take_along_dim(x, i, dim=axis))(x, idx_e, axis=1)
        g = _silu(x_sel @ w_gate)
        u = x_sel @ w_up
        y = (g * u) @ w_down
        r_sel = _sigmoid((lambda x, i, axis: torch.take_along_dim(x, i, dim=axis))(r, idx, axis=1))
        y = y * r_sel.reshape(B, C, 1)
        b_off = (torch.arange(B) * S).reshape(B, 1)
        flat_idx = (idx + b_off).reshape(B * C)
        zero = (x * 0.0).reshape(B * S, D)
        upd = _scatter_add(zero, flat_idx, y.reshape(B * C, D), axis=0)
        return x + upd.reshape(B, S, D)

    x = A_u
    xn = _layernorm(x, axis=-1)
    s = _A_ref(xn, A_A_re, A_A_im, A_B_re, A_B_im, A_C_re, A_C_im, A_log_dt, A_Dskip)
    g = _silu(_B_ref(xn, B_w_r, B_w_gate, B_w_up, B_w_down))
    return x + s * g
```

```asm
; @launch grid=(256,1,1) block=(512,1,1) lds=157568
.amdgcn_target "amdgcn-amd-amdhsa--gfx950"
.text
.globl recurrent_scan__ssm_conv_s4__moe_arch_mod__prompt_kernel
.p2align 12
.fill 832, 4, 0xbf810000
.p2align 8
.type recurrent_scan__ssm_conv_s4__moe_arch_mod__prompt_kernel,@function
recurrent_scan__ssm_conv_s4__moe_arch_mod__prompt_kernel:
    s_load_dwordx16 s[4:19], s[0:1], 0
    s_load_dwordx16 s[20:35], s[0:1], 64
    s_load_dwordx2 s[36:37], s[0:1], 128
    s_getpc_b64 s[84:85]
L_pc0:
    v_lshrrev_b32 v2, 6, v0
    v_and_b32 v1, 63, v0
    v_readfirstlane_b32 s39, v2
    s_cmp_ge_u32 s2, 256
    s_cbranch_scc1 L_exit0
    s_and_b32 s40, s2, 120
    v_add_lshl_u32 v230, v2, s40, 8
    v_and_b32 v229, 1, v0
    v_lshl_add_u32 v230, v229, 7, v230
    v_min_u32 v230, L_data_end-L_pc0-4, v230
    s_cmp_ge_u32 s2, 128
    s_cbranch_scc1 L_notln
    s_lshl_b32 s40, s2, 3
    s_add_u32 s40, s40, s39
    s_mul_i32 s40, s40, 1792
    v_lshlrev_b32 v7, 4, v1
    v_add_u32 v6, s40, v7
    v_mov_b32 v8, 0
    v_mov_b32 v9, 0
    v_mov_b32 v10, 0
    v_mov_b32 v11, 0
    v_mov_b32 v12, 0
    v_mov_b32 v13, 0
    v_mov_b32 v14, 0
    v_mov_b32 v15, 0
    v_mov_b32 v16, 0
    v_mov_b32 v17, 0
    v_mov_b32 v18, 0
    v_mov_b32 v19, 0
    v_mov_b32 v20, 0
    s_mov_b32 exec_hi, 0x00ffffff
    s_waitcnt lgkmcnt(0)
    global_load_dwordx4 v[8:11], v6, s[4:5]
    global_load_dwordx4 v[12:15], v6, s[4:5] offset:896
    global_load_dwordx4 v[16:19], v7, s[24:25]
    global_load_dword v45, v20, s[36:37] sc1
    s_mov_b64 exec, -1
    s_branch L_ln_body
L_notln:
    s_and_b32 s40, s2, 7
    s_lshr_b32 s41, s2, 3
    s_cmp_eq_u32 s40, 7
    s_cbranch_scc1 L_x7
    s_and_b32 s41, s41, 15
    s_lshl4_add_u32 s42, s40, s41
    s_and_b32 s45, s39, 3
    s_cmp_lt_u32 s39, 4
    s_cselect_b32 s88, 1, 0
    s_lshl2_add_u32 s44, s42, s45
    s_lshl1_add_u32 s44, s44, s88
    s_lshl_b32 s44, s44, 8
    s_lshl_b32 s58, s42, 3
    s_lshl_b32 s52, s39, 8
    s_add_u32 s53, s52, 49536
    s_mov_b32 m0, s53
    s_lshl_b32 s59, s45, 8
    s_mov_b32 s43, 0xffff0000
    v_mov_b32 v20, 0
    v_lshlrev_b32 v24, 2, v1
    v_mov_b32 v25, 0x3c00
    v_add_u32 v2, s44, v24
    v_add_u32 v24, 138624, v24
    ds_write2st64_b32 v24, v20, v20 offset1:1
    ds_write_addtid_b32 v25 offset:0
    v_and_b32 v8, 31, v1
    v_lshrrev_b32 v26, 5, v1
    v_mul_u32_u24 v9, 2064, v8
    v_writelane_b32 v8, 4, 8
    v_writelane_b32 v8, 4, 40
    v_writelane_b32 v8, 11, 13
    v_writelane_b32 v8, 11, 45
    v_writelane_b32 v8, 13, 27
    v_writelane_b32 v8, 13, 59
    v_lshlrev_b32 v26, 4, v26
    v_and_b32 v3, 15, v1
    v_mul_u32_u24 v8, 2064, v8
    v_add3_u32 v9, v9, v26, s53
    v_add3_u32 v8, v8, v26, s52
    v_lshrrev_b32 v4, 4, v1
    v_mul_u32_u24 v27, 2064, v4
    v_lshlrev_b32 v4, 3, v4
    v_lshl_add_u32 v27, v3, 4, v27
    global_load_dword v231, v230, s[84:85]
    s_waitcnt lgkmcnt(0)
    s_load_dwordx2 s[60:61], s[18:19], s58
    global_load_dword v10, v2, s[6:7]
    global_load_dword v11, v2, s[8:9]
    s_load_dwordx2 s[62:63], s[20:21], s58
    s_barrier
    global_load_dword v12, v2, s[10:11]
    global_load_dword v13, v2, s[12:13]
    global_load_dword v14, v2, s[14:15]
    global_load_dword v15, v2, s[16:17]
    v_add_u32 v20, s59, v27
    s_cmp_eq_u32 s88, 0
    s_cbranch_scc1 L_msetup
    s_lshl_b32 s44, s45, 6
    v_add_u32 v26, s44, v1
    v_mul_u32_u24 v248, 1792, v26
    v_add_u32 v248, s58, v248
    v_add_u32 v249, 458752, v248
    v_add_u32 v250, 917504, v248
    v_add_u32 v251, 1376256, v248
    v_lshlrev_b32 v252, 4, v26
    v_add_u32 v252, 20480, v252
    v_add_u32 v253, 8192, v252
    v_lshlrev_b32 v29, 2, v26
    v_add_u32 v29, 139648, v29
    s_and_b32 s44, s45, 1
    s_lshl_b32 s44, s44, 6
    v_add_u32 v24, s44, v1
    v_lshrrev_b32 v25, 3, v24
    v_lshlrev_b32 v25, 4, v25
    v_bfe_u32 v26, v24, 1, 2
    v_mul_u32_u24 v26, 8256, v26
    v_and_b32 v27, 1, v24
    v_lshlrev_b32 v27, 3, v27
    v_add3_u32 v25, v25, v26, v27
    s_lshr_b32 s44, s45, 1
    s_mul_i32 s46, s44, 2064
    v_add_u32 v255, s46, v25
    s_lshl_b32 s44, s44, 4
    v_and_b32 v27, 3, v1
    v_lshlrev_b32 v27, 2, v27
    v_add_u32 v27, 138624, v27
    v_add_u32 v28, s44, v27
    s_lshl_b32 s44, s45, 2
    s_add_u32 s44, s44, 138624
    v_mov_b32 v24, s44
    v_mov_b32 v25, 138624
    v_mov_b32 v26, 0
    s_mov_b32 s80, s32
    s_and_b32 s81, s33, 0xffff
    s_mov_b32 s82, 1835008
    s_mov_b32 s83, 0x20000
    s_cmp_eq_u32 s45, 0
    s_cselect_b32 s94, 1, 0
    s_mul_i32 s46, s45, 5760
    s_add_u32 s46, s46, 115584
    v_mov_b32 v36, 0
    v_mov_b32 v37, 0
    v_mov_b32 v38, 0
    v_mov_b32 v39, 0
    v_lshl_add_u32 v33, v1, 4, s46
    ds_write_b128 v33, v[36:39]
    ds_write_b128 v33, v[36:39] offset:1024
    ds_write_b128 v33, v[36:39] offset:2048
    ds_write_b128 v33, v[36:39] offset:3072
    ds_write_b128 v33, v[36:39] offset:4096
    ds_write_b128 v33, v[36:39] offset:4736
    s_mul_i32 s44, s45, 4608
    s_add_u32 s44, s44, 139136
    v_lshl_add_u32 v33, v1, 3, s44
    ds_write_b64 v33, v[36:37]
    s_branch L_setupdone
L_msetup:
    s_mul_i32 s46, s45, 5760
    s_add_u32 s46, s46, 115584
    s_lshl_b32 s44, s41, 7
    v_bfe_u32 v5, v0, 1, 7
    v_add_u32 v5, s44, v5
    s_lshl_b32 s44, s40, 7
    v_mul_u32_u24 v5, 896, v5
    v_add_u32 v5, s44, v5
    v_and_b32 v33, 31, v1
    v_lshrrev_b32 v34, 5, v1
    v_lshl_add_u32 v35, v33, 1, v34
    v_lshlrev_b32 v35, 3, v35
    s_add_u32 s44, s46, 568
    v_sub_u32 v22, s44, v35
    v_add_u32 v27, 1220, v22
    v_add_u32 v6, 2436, v22
    v_mul_u32_u24 v36, 43, v1
    v_lshrrev_b32 v36, 7, v36
    v_mul_u32_u24 v37, 1212, v36
    v_lshl_add_u32 v37, v1, 1, v37
    v_add_u32 v37, 60, v37
    s_movk_i32 s44, 1088
    v_writelane_b32 v37, s44, 2
    s_movk_i32 s44, 3524
    v_writelane_b32 v37, s44, 8
    v_min_u32 v37, 4860, v37
    v_add_u32 v178, s46, v37
    s_add_u32 s44, s46, 5244
    v_lshlrev_b32 v35, 2, v1
    v_sub_u32 v23, s44, v35
    v_lshl_add_u32 v35, v34, 6, v33
    v_lshlrev_b32 v35, 1, v35
    s_add_u32 s44, s46, 5566
    v_sub_u32 v24, s44, v35
    v_mov_b32 v25, s46
    v_sub_u32 v33, v4, v3
    v_lshlrev_b32 v33, 1, v33
    v_and_b32 v34, 3, v3
    v_mul_u32_u24 v34, 1218, v34
    s_add_u32 s44, s46, 32
    v_add3_u32 v26, v33, v34, s44
    v_lshlrev_b32 v33, 2, v4
    v_lshlrev_b32 v34, 3, v3
    v_sub_u32 v33, v33, v34
    s_add_u32 s44, s46, 4984
    v_add_u32 v28, s44, v33
    v_lshlrev_b32 v33, 1, v3
    v_sub_u32 v33, v4, v33
    v_lshlrev_b32 v33, 1, v33
    s_add_u32 s44, s46, 5436
    v_add_u32 v29, s44, v33
    s_mul_i32 s44, s45, 4608
    s_add_u32 s44, s44, 139136
    v_lshlrev_b32 v2, 5, v3
    v_lshl_add_u32 v2, v4, 1, v2
    v_add_u32 v2, s44, v2
    v_mul_u32_u24 v33, 1032, v4
    v_lshl_add_u32 v33, v3, 4, v33
    v_add_u32 v21, s52, v33
    s_lshl_b32 s44, s45, 2
    s_add_u32 s44, s44, 138624
    v_mov_b32 v31, s44
    v_and_b32 v33, 3, v1
    v_lshlrev_b32 v33, 2, v33
    v_add_u32 v0, 138624, v33
    v_mov_b32 v7, 0
    v_mov_b32 v33, 56
    v_lshlrev_b32 v33, v3, v33
    v_bfe_u32 v33, v33, v4, 8
    v_lshl_or_b32 v33, v33, 15, v33
    v_and_b32 v34, 65537, v33
    v_mul_u32_u24 v232, 16256, v34
    v_and_b32 v34, 262148, v33
    v_mul_u32_u24 v233, 4064, v34
    v_and_b32 v34, 1048592, v33
    v_mul_u32_u24 v234, 1016, v34
    v_and_b32 v34, 4194368, v33
    v_mul_u32_u24 v235, 254, v34
    v_mov_b32 v33, 1984
    v_lshlrev_b32 v33, v3, v33
    v_bfe_u32 v33, v33, v4, 8
    v_lshl_or_b32 v33, v33, 15, v33
    v_and_b32 v34, 65537, v33
    v_mul_u32_u24 v236, 16256, v34
    v_and_b32 v34, 262148, v33
    v_mul_u32_u24 v237, 4064, v34
    v_and_b32 v34, 1048592, v33
    v_mul_u32_u24 v238, 1016, v34
    v_and_b32 v34, 4194368, v33
    v_mul_u32_u24 v239, 254, v34
L_setupdone:
    s_waitcnt lgkmcnt(0)
    s_lshl_b32 s44, s45, 4
    s_lshr_b64 s[60:61], s[60:61], s44
    s_lshl_b32 s60, s60, 16
    s_lshr_b64 s[62:63], s[62:63], s44
    s_lshl_b32 s62, s62, 16
    v_writelane_b32 v7, s62, 0
    v_mov_b32 v32, 0x3fb8aa3b
    v_mul_f32 v33, s60, v32
    v_fma_f32 v34, s60, v32, -v33
    v_mov_b32 v35, 0x32a57060
    v_fma_f32 v34, s60, v35, v34
    v_exp_f32 v33, v33
    v_mul_f32 v34, 0x3f317218, v34
    v_mov_b32 v32, 0x3fa2f983
    v_fma_f32 v33, v33, v34, v33
    v_cvt_pk_bf16_f32 v19, 0, v33
    v_mov_b32 v35, 0x335c9c88
    v_mul_f32 v17, v19, v32
    v_mul_f32 v16, 0x4138aa3b, v19
    v_fma_f32 v18, v19, v32, -v17
    v_fma_f32 v18, v19, v35, v18
    s_mov_b32 s63, 0x3ef5fdf0
    v_mul_f32 v19, s63, v19
    s_cmp_eq_u32 s88, 0
    s_cbranch_scc0 L_helper
    s_waitcnt vmcnt(4)
    global_load_dword v231, v5, s[4:5]
    v_lshlrev_b32 v183, 16, v11
    v_lshlrev_b32 v180, 16, v10
    v_mul_f32 v181, v183, v17
    v_mul_f32 v180, v180, v16
    v_fma_f32 v182, v183, v17, -v181
    v_fract_f32 v185, v181
    v_fma_f32 v182, v183, v18, v182
    v_exp_f32 v183, v180
    v_add_f32 v185, v185, v182
    v_cos_f32 v184, v185
    v_sin_f32 v185, v185
    v_mul_f32 v184, v184, v183
    v_mul_f32 v185, v185, v183
    v_cvt_pk_f16_f32 v115, v184, v185
    s_mov_b32 m0, s53
    v_mul_f32 v186, v185, v185
    v_mul_f32 v181, 0x3e000000, v181
    v_mul_f32 v187, v184, v185 mul:2
    v_fma_f32 v186, v184, v184, -v186
    v_mul_f32 v180, 0x3e000000, v180
    v_cvt_pk_f16_f32 v116, v186, v187
    v_fract_f32 v189, v181
    v_pk_mul_f16 v139, v115, v116 op_sel:[0,0] op_sel_hi:[0,1]
    v_pk_fma_f16 v139, v115, v116, v139 op_sel:[1,1,0] op_sel_hi:[1,0,1] neg_lo:[1,0,0]
    v_exp_f32 v182, v180
    v_mul_f32 v184, v187, v187
    v_mul_f32 v185, v186, v187 mul:2
    v_cos_f32 v188, v189
    v_fma_f32 v184, v186, v186, -v184
    v_cvt_pk_f16_f32 v117, v184, v185
    v_sin_f32 v189, v189
    ds_write_addtid_b32 v115 offset:2064
    ds_write_addtid_b32 v116 offset:4128
    ds_write_addtid_b32 v139 offset:6192
    ds_write_addtid_b32 v117 offset:8256
    v_pk_mul_f16 v141, v115, v117 op_sel:[0,0] op_sel_hi:[0,1]
    v_mul_f32 v188, v188, v182
    v_pk_fma_f16 v141, v115, v117, v141 op_sel:[1,1,0] op_sel_hi:[1,0,1] neg_lo:[1,0,0]
    v_pk_mul_f16 v142, v116, v117 op_sel:[0,0] op_sel_hi:[0,1]
    v_mul_f32 v189, v189, v182
    v_pk_fma_f16 v142, v116, v117, v142 op_sel:[1,1,0] op_sel_hi:[1,0,1] neg_lo:[1,0,0]
    v_cvt_pk_f16_f32 v112, v188, v189
    v_pk_mul_f16 v143, v139, v117 op_sel:[0,0] op_sel_hi:[0,1]
    v_pk_fma_f16 v143, v139, v117, v143 op_sel:[1,1,0] op_sel_hi:[1,0,1] neg_lo:[1,0,0]
    v_pk_mul_f16 v113, v112, v112 op_sel:[0,0] op_sel_hi:[0,1]
    v_mul_f32 v186, v185, v185
    v_pk_fma_f16 v113, v112, v112, v113 op_sel:[1,1,0] op_sel_hi:[1,0,1] neg_lo:[1,0,0]
    v_mul_f32 v187, v184, v185 mul:2
    v_fma_f32 v186, v184, v184, -v186
    v_cvt_pk_f16_f32 v118, v186, v187
    v_pk_mul_f16 v114, v113, v113 op_sel:[0,0] op_sel_hi:[0,1]
    ds_write_addtid_b32 v141 offset:10320
    ds_write_addtid_b32 v142 offset:12384
    ds_write_addtid_b32 v143 offset:14448
    ds_write_addtid_b32 v118 offset:16512
    v_pk_mul_f16 v145, v115, v118 op_sel:[0,0] op_sel_hi:[0,1]
    v_pk_fma_f16 v114, v113, v113, v114 op_sel:[1,1,0] op_sel_hi:[1,0,1] neg_lo:[1,0,0]
    v_pk_fma_f16 v145, v115, v118, v145 op_sel:[1,1,0] op_sel_hi:[1,0,1] neg_lo:[1,0,0]
    ds_write_addtid_b32 v145 offset:18576
    s_waitcnt vmcnt(1)
    v_pk_mul_f16 v146, v116, v118 op_sel:[0,0] op_sel_hi:[0,1]
    v_pk_fma_f16 v146, v116, v118, v146 op_sel:[1,1,0] op_sel_hi:[1,0,1] neg_lo:[1,0,0]
    v_lshlrev_b32 v216, 16, v12
    v_pk_mul_f16 v147, v139, v118 op_sel:[0,0] op_sel_hi:[0,1]
    v_pk_fma_f16 v147, v139, v118, v147 op_sel:[1,1,0] op_sel_hi:[1,0,1] neg_lo:[1,0,0]
    v_lshlrev_b32 v217, 16, v13
    v_pk_mul_f16 v148, v117, v118 op_sel:[0,0] op_sel_hi:[0,1]
    v_lshlrev_b32 v218, 16, v14
    v_pk_fma_f16 v148, v117, v118, v148 op_sel:[1,1,0] op_sel_hi:[1,0,1] neg_lo:[1,0,0]
    v_lshlrev_b32 v219, 16, v15
    v_pk_mul_f16 v149, v141, v118 op_sel:[0,0] op_sel_hi:[0,1]
    v_pk_fma_f16 v149, v141, v118, v149 op_sel:[1,1,0] op_sel_hi:[1,0,1] neg_lo:[1,0,0]
    v_mul_f32 v212, v218, v216
    ds_write_addtid_b32 v146 offset:20640
    ds_write_addtid_b32 v147 offset:22704
    ds_write_addtid_b32 v148 offset:24768
    ds_write_addtid_b32 v149 offset:26832
    v_pk_mul_f16 v150, v142, v118 op_sel:[0,0] op_sel_hi:[0,1]
    v_pk_fma_f16 v150, v142, v118, v150 op_sel:[1,1,0] op_sel_hi:[1,0,1] neg_lo:[1,0,0]
    v_mul_f32 v213, v218, v217
    v_pk_mul_f16 v151, v143, v118 op_sel:[0,0] op_sel_hi:[0,1]
    v_fma_f32 v212, -v219, v217, v212
    v_pk_fma_f16 v151, v143, v118, v151 op_sel:[1,1,0] op_sel_hi:[1,0,1] neg_lo:[1,0,0]
    v_fma_f32 v213, -v219, v216, -v213
    v_mul_f32 v184, v187, v187
    v_mul_f32 v185, v186, v187 mul:2
    v_and_b32 v216, s43, v12
    v_fma_f32 v184, v186, v186, -v184
    v_cvt_pk_f16_f32 v119, v184, v185
    v_and_b32 v217, s43, v13
    v_pk_mul_f16 v228, v115, v119 op_sel:[0,0] op_sel_hi:[0,1]
    v_and_b32 v218, s43, v14
    v_pk_fma_f16 v228, v115, v119, v228 op_sel:[1,1,0] op_sel_hi:[1,0,1] neg_lo:[1,0,0]
    ds_write_addtid_b32 v150 offset:28896
    ds_write_addtid_b32 v151 offset:30960
    ds_write_addtid_b32 v119 offset:33024
    ds_write_addtid_b32 v228 offset:35088
    v_and_b32 v219, s43, v15
    v_pk_mul_f16 v229, v116, v119 op_sel:[0,0] op_sel_hi:[0,1]
    v_mul_f32 v214, v218, v216
    v_pk_fma_f16 v229, v116, v119, v229 op_sel:[1,1,0] op_sel_hi:[1,0,1] neg_lo:[1,0,0]
    v_mul_f32 v215, v218, v217
    v_pk_mul_f16 v230, v139, v119 op_sel:[0,0] op_sel_hi:[0,1]
    v_fma_f32 v214, -v219, v217, v214
    v_pk_fma_f16 v230, v139, v119, v230 op_sel:[1,1,0] op_sel_hi:[1,0,1] neg_lo:[1,0,0]
    v_fma_f32 v215, -v219, v216, -v215
    v_pk_mul_f16 v221, v117, v119 op_sel:[0,0] op_sel_hi:[0,1]
    v_pk_fma_f16 v221, v117, v119, v221 op_sel:[1,1,0] op_sel_hi:[1,0,1] neg_lo:[1,0,0]
    v_max3_f32 v220, |v212|, |v213|, |v214|
    v_max_f32 v220, v220, |v215|
    v_pk_mul_f16 v222, v141, v119 op_sel:[0,0] op_sel_hi:[0,1]
    v_pk_fma_f16 v222, v141, v119, v222 op_sel:[1,1,0] op_sel_hi:[1,0,1] neg_lo:[1,0,0]
    v_max_u32_dpp v220, v220, v220 quad_perm:[1,0,3,2] row_mask:0xf bank_mask:0xf
    ds_write_addtid_b32 v229 offset:37152
    ds_write_addtid_b32 v230 offset:39216
    ds_write_addtid_b32 v221 offset:41280
    ds_write_addtid_b32 v222 offset:43344
    v_max_u32_dpp v220, v220, v220 quad_perm:[2,3,0,1] row_mask:0xf bank_mask:0xf
    v_pk_mul_f16 v223, v142, v119 op_sel:[0,0] op_sel_hi:[0,1]
    v_pk_fma_f16 v223, v142, v119, v223 op_sel:[1,1,0] op_sel_hi:[1,0,1] neg_lo:[1,0,0]
    v_max_u32_dpp v220, v220, v220 row_half_mirror row_mask:0xf bank_mask:0xf
    v_pk_mul_f16 v224, v143, v119 op_sel:[0,0] op_sel_hi:[0,1]
    s_nop 0
    v_max_u32_dpp v220, v220, v220 row_mirror row_mask:0xf bank_mask:0xf
    v_pk_fma_f16 v224, v143, v119, v224 op_sel:[1,1,0] op_sel_hi:[1,0,1] neg_lo:[1,0,0]
    s_nop 0
    v_max_u32_dpp v220, v220, v220 row_bcast:15 row_mask:0xa bank_mask:0xf
    v_pk_mul_f16 v225, v118, v119 op_sel:[0,0] op_sel_hi:[0,1]
    s_nop 0
    v_max_u32_dpp v220, v220, v220 row_bcast:31 row_mask:0xc bank_mask:0xf
    v_pk_fma_f16 v225, v118, v119, v225 op_sel:[1,1,0] op_sel_hi:[1,0,1] neg_lo:[1,0,0]
    v_readlane_b32 s50, v220, 63
    v_pk_mul_f16 v226, v145, v119 op_sel:[0,0] op_sel_hi:[0,1]
    s_lshr_b32 s50, s50, 23
    s_sub_u32 s50, 267, s50
    s_min_u32 s50, s50, 253
    s_sub_u32 s51, 254, s50
    s_lshl_b32 s50, s50, 23
    s_lshl_b32 s51, s51, 23
    v_pk_fma_f16 v226, v145, v119, v226 op_sel:[1,1,0] op_sel_hi:[1,0,1] neg_lo:[1,0,0]
    v_mul_f32 v212, s50, v212
    ds_write_addtid_b32 v223 offset:45408
    ds_write_addtid_b32 v224 offset:47472
    ds_write_addtid_b32 v225 offset:49536
    ds_write_addtid_b32 v226 offset:51600
    v_pk_mul_f16 v227, v146, v119 op_sel:[0,0] op_sel_hi:[0,1]
    v_mul_f32 v213, s50, v213
    v_pk_fma_f16 v227, v146, v119, v227 op_sel:[1,1,0] op_sel_hi:[1,0,1] neg_lo:[1,0,0]
    v_mul_f32 v214, s50, v214
    v_pk_mul_f16 v228, v147, v119 op_sel:[0,0] op_sel_hi:[0,1]
    v_mul_f32 v215, s50, v215
    v_pk_fma_f16 v228, v147, v119, v228 op_sel:[1,1,0] op_sel_hi:[1,0,1] neg_lo:[1,0,0]
    v_mul_f32 v19, s51, v19
    v_pk_mul_f16 v229, v148, v119 op_sel:[0,0] op_sel_hi:[0,1]
    v_mul_f32 v186, v185, v185
    v_pk_fma_f16 v229, v148, v119, v229 op_sel:[1,1,0] op_sel_hi:[1,0,1] neg_lo:[1,0,0]
    v_mul_f32 v187, v184, v185 mul:2
    v_pk_mul_f16 v230, v149, v119 op_sel:[0,0] op_sel_hi:[0,1]
    v_pk_fma_f16 v230, v149, v119, v230 op_sel:[1,1,0] op_sel_hi:[1,0,1] neg_lo:[1,0,0]
    v_fma_f32 v186, v184, v184, -v186
    ds_write_addtid_b32 v227 offset:53664
    ds_write_addtid_b32 v228 offset:55728
    ds_write_addtid_b32 v229 offset:57792
    ds_write_addtid_b32 v230 offset:59856
    v_cvt_pk_f16_f32 v120, v186, v187
    v_pk_mul_f16 v221, v150, v119 op_sel:[0,0] op_sel_hi:[0,1]
    v_pk_fma_f16 v221, v150, v119, v221 op_sel:[1,1,0] op_sel_hi:[1,0,1] neg_lo:[1,0,0]
    v_pk_mul_f16 v121, v120, v120 op_sel:[0,0] op_sel_hi:[0,1]
    v_pk_fma_f16 v121, v120, v120, v121 op_sel:[1,1,0] op_sel_hi:[1,0,1] neg_lo:[1,0,0]
    v_pk_mul_f16 v222, v151, v119 op_sel:[0,0] op_sel_hi:[0,1]
    v_pk_fma_f16 v222, v151, v119, v222 op_sel:[1,1,0] op_sel_hi:[1,0,1] neg_lo:[1,0,0]
    v_pk_mul_f16 v122, v121, v121 op_sel:[0,0] op_sel_hi:[0,1]
    v_pk_fma_f16 v122, v121, v121, v122 op_sel:[1,1,0] op_sel_hi:[1,0,1] neg_lo:[1,0,0]
    v_cvt_pk_f16_f32 v156, v212, v213
    ds_write_addtid_b32 v221 offset:61920
    ds_write_addtid_b32 v222 offset:63984
    s_mov_b32 m0, s52
    v_pk_mul_f16 v157, v156, v112 op_sel:[0,0] op_sel_hi:[0,1] neg_hi:[1,0]
    v_pk_fma_f16 v157, v156, v112, v157 op_sel:[1,1,0] op_sel_hi:[1,0,1]
    ds_read_b128 v[48:51], v9 offset:0
    ds_write_addtid_b32 v156 offset:0
    ds_read_b128 v[52:55], v9 offset:32
    ds_read_b128 v[56:59], v9 offset:64
    v_pk_mul_f16 v158, v156, v113 op_sel:[0,0] op_sel_hi:[0,1] neg_hi:[1,0]
    v_pk_fma_f16 v158, v156, v113, v158 op_sel:[1,1,0] op_sel_hi:[1,0,1]
    ds_write_addtid_b32 v157 offset:2064
    ds_read_b128 v[60:63], v9 offset:96
    ds_read_b128 v[64:67], v9 offset:128
    ds_write_addtid_b32 v158 offset:4128
    v_pk_mul_f16 v159, v157, v113 op_sel:[0,0] op_sel_hi:[0,1] neg_hi:[1,0]
    v_pk_fma_f16 v159, v157, v113, v159 op_sel:[1,1,0] op_sel_hi:[1,0,1]
    v_pk_mul_f16 v160, v156, v114 op_sel:[0,0] op_sel_hi:[0,1] neg_hi:[1,0]
    ds_read_b128 v[68:71], v9 offset:160
    ds_write_addtid_b32 v159 offset:6192
    ds_read_b128 v[72:75], v9 offset:192
    ds_read_b128 v[76:79], v9 offset:224
    v_pk_fma_f16 v160, v156, v114, v160 op_sel:[1,1,0] op_sel_hi:[1,0,1]
    v_and_b32 v199, s43, v11
    v_pk_mul_f16 v161, v157, v114 op_sel:[0,0] op_sel_hi:[0,1] neg_hi:[1,0]
    v_and_b32 v196, s43, v10
    v_pk_fma_f16 v161, v157, v114, v161 op_sel:[1,1,0] op_sel_hi:[1,0,1]
    v_mul_f32 v197, v199, v17
    v_pk_mul_f16 v162, v158, v114 op_sel:[0,0] op_sel_hi:[0,1] neg_hi:[1,0]
    v_mul_f32 v196, v196, v16
    v_pk_fma_f16 v162, v158, v114, v162 op_sel:[1,1,0] op_sel_hi:[1,0,1]
    v_fma_f32 v198, v199, v17, -v197
    v_pk_mul_f16 v163, v159, v114 op_sel:[0,0] op_sel_hi:[0,1] neg_hi:[1,0]
    v_pk_fma_f16 v163, v159, v114, v163 op_sel:[1,1,0] op_sel_hi:[1,0,1]
    v_fract_f32 v201, v197
    ds_write_addtid_b32 v160 offset:8256
    ds_write_addtid_b32 v161 offset:10320
    ds_write_addtid_b32 v162 offset:12384
    ds_write_addtid_b32 v163 offset:14448
    v_fma_f32 v198, v199, v18, v198
    v_pk_mul_f16 v164, v156, v115 op_sel:[0,0] op_sel_hi:[0,1] neg_hi:[1,0]
    v_pk_fma_f16 v164, v156, v115, v164 op_sel:[1,1,0] op_sel_hi:[1,0,1]
    v_exp_f32 v199, v196
    v_add_f32 v201, v201, v198
    v_pk_mul_f16 v165, v156, v120 op_sel:[0,0] op_sel_hi:[0,1] neg_hi:[1,0]
    v_pk_fma_f16 v165, v156, v120, v165 op_sel:[1,1,0] op_sel_hi:[1,0,1]
    v_cos_f32 v200, v201
    v_sin_f32 v201, v201
    v_pk_mul_f16 v166, v158, v120 op_sel:[0,0] op_sel_hi:[0,1] neg_hi:[1,0]
    v_pk_fma_f16 v166, v158, v120, v166 op_sel:[1,1,0] op_sel_hi:[1,0,1]
    v_mul_f32 v200, v200, v199
    v_pk_mul_f16 v167, v160, v120 op_sel:[0,0] op_sel_hi:[0,1] neg_hi:[1,0]
    v_mul_f32 v201, v201, v199
    v_pk_fma_f16 v167, v160, v120, v167 op_sel:[1,1,0] op_sel_hi:[1,0,1]
    v_cvt_pk_f16_f32 v127, v200, v201
    ds_write_addtid_b32 v164 offset:24768
    ds_write_addtid_b32 v165 offset:18576
    ds_write_addtid_b32 v166 offset:20640
    ds_write_addtid_b32 v167 offset:22704
    v_pk_mul_f16 v168, v162, v120 op_sel:[0,0] op_sel_hi:[0,1] neg_hi:[1,0]
    v_mul_f32 v202, v201, v201
    v_pk_fma_f16 v168, v162, v120, v168 op_sel:[1,1,0] op_sel_hi:[1,0,1]
    v_mul_f32 v203, v200, v201 mul:2
    v_pk_mul_f16 v169, v164, v120 op_sel:[0,0] op_sel_hi:[0,1] neg_hi:[1,0]
    v_fma_f32 v202, v200, v200, -v202
    v_pk_fma_f16 v169, v164, v120, v169 op_sel:[1,1,0] op_sel_hi:[1,0,1]
    v_cvt_pk_f16_f32 v128, v202, v203
    v_pk_mul_f16 v170, v160, v121 op_sel:[0,0] op_sel_hi:[0,1] neg_hi:[1,0]
    v_mul_f32 v200, v203, v203
    v_pk_fma_f16 v170, v160, v121, v170 op_sel:[1,1,0] op_sel_hi:[1,0,1]
    v_mul_f32 v201, v202, v203 mul:2
    v_pk_mul_f16 v171, v164, v121 op_sel:[0,0] op_sel_hi:[0,1] neg_hi:[1,0]
    v_fma_f32 v200, v202, v202, -v200
    v_pk_fma_f16 v171, v164, v121, v171 op_sel:[1,1,0] op_sel_hi:[1,0,1]
    ds_write_addtid_b32 v168 offset:28896
    ds_write_addtid_b32 v169 offset:30960
    ds_write_addtid_b32 v170 offset:33024
    ds_write_addtid_b32 v171 offset:35088
    s_setprio 1
    v_cvt_pk_f16_f32 v129, v200, v201
    v_pk_mul_f16 v172, v167, v121 op_sel:[0,0] op_sel_hi:[0,1] neg_hi:[1,0]
    v_mul_f32 v202, v201, v201
    v_pk_fma_f16 v172, v167, v121, v172 op_sel:[1,1,0] op_sel_hi:[1,0,1]
    v_mul_f32 v203, v200, v201 mul:2
    v_pk_mul_f16 v173, v169, v121 op_sel:[0,0] op_sel_hi:[0,1] neg_hi:[1,0]
    v_fma_f32 v202, v200, v200, -v202
    v_pk_fma_f16 v173, v169, v121, v173 op_sel:[1,1,0] op_sel_hi:[1,0,1]
    v_cvt_pk_f16_f32 v130, v202, v203
    v_pk_mul_f16 v174, v164, v122 op_sel:[0,0] op_sel_hi:[0,1] neg_hi:[1,0]
    v_pk_fma_f16 v174, v164, v122, v174 op_sel:[1,1,0] op_sel_hi:[1,0,1]
    v_mul_f32 v200, v203, v203
    v_mul_f32 v201, v202, v203 mul:2
    v_pk_mul_f16 v175, v169, v122 op_sel:[0,0] op_sel_hi:[0,1] neg_hi:[1,0]
    v_pk_fma_f16 v175, v169, v122, v175 op_sel:[1,1,0] op_sel_hi:[1,0,1]
    v_fma_f32 v200, v202, v202, -v200
    ds_write_addtid_b32 v172 offset:41280
    ds_write_addtid_b32 v173 offset:43344
    ds_write_addtid_b32 v174 offset:37152
    ds_write_addtid_b32 v175 offset:39216
    v_cvt_pk_f16_f32 v131, v200, v201
    v_pk_mul_f16 v176, v171, v122 op_sel:[0,0] op_sel_hi:[0,1] neg_hi:[1,0]
    v_pk_fma_f16 v176, v171, v122, v176 op_sel:[1,1,0] op_sel_hi:[1,0,1]
    v_mul_f32 v202, v201, v201
    v_mul_f32 v203, v200, v201 mul:2
    v_pk_mul_f16 v177, v173, v122 op_sel:[0,0] op_sel_hi:[0,1] neg_hi:[1,0]
    v_pk_fma_f16 v177, v173, v122, v177 op_sel:[1,1,0] op_sel_hi:[1,0,1]
    v_fma_f32 v202, v200, v200, -v202
    v_cvt_pk_f16_f32 v132, v202, v203
    ds_write_addtid_b32 v176 offset:45408
    ds_write_addtid_b32 v177 offset:47472
    ds_read_b128 v[80:83], v8 offset:0
    ds_read_b128 v[84:87], v8 offset:32
    ds_read_b128 v[88:91], v8 offset:64
    ds_read_b128 v[92:95], v8 offset:96
    ds_read_b128 v[96:99], v8 offset:128
    ds_read_b128 v[100:103], v8 offset:160
    ds_read_b128 v[104:107], v8 offset:192
    ds_read_b128 v[108:111], v8 offset:224
    s_mov_b32 m0, s53
    v_pk_mul_f16 v133, v132, v132 op_sel:[0,0] op_sel_hi:[0,1]
    v_pk_mul_f16 v139, v127, v128 op_sel:[0,0] op_sel_hi:[0,1]
    v_pk_fma_f16 v139, v127, v128, v139 op_sel:[1,1,0] op_sel_hi:[1,0,1] neg_lo:[1,0,0]
    v_pk_fma_f16 v133, v132, v132, v133 op_sel:[1,1,0] op_sel_hi:[1,0,1] neg_lo:[1,0,0]
    ds_write_addtid_b32 v127 offset:2064
    ds_write_addtid_b32 v128 offset:4128
    ds_write_addtid_b32 v139 offset:6192
    ds_write_addtid_b32 v129 offset:8256
    v_pk_mul_f16 v141, v127, v129 op_sel:[0,0] op_sel_hi:[0,1]
    v_pk_fma_f16 v141, v127, v129, v141 op_sel:[1,1,0] op_sel_hi:[1,0,1] neg_lo:[1,0,0]
    v_pk_mul_f16 v134, v133, v133 op_sel:[0,0] op_sel_hi:[0,1]
    v_pk_mul_f16 v142, v128, v129 op_sel:[0,0] op_sel_hi:[0,1]
    v_pk_fma_f16 v142, v128, v129, v142 op_sel:[1,1,0] op_sel_hi:[1,0,1] neg_lo:[1,0,0]
    v_pk_fma_f16 v134, v133, v133, v134 op_sel:[1,1,0] op_sel_hi:[1,0,1] neg_lo:[1,0,0]
    v_pk_mul_f16 v143, v139, v129 op_sel:[0,0] op_sel_hi:[0,1]
    v_pk_fma_f16 v143, v139, v129, v143 op_sel:[1,1,0] op_sel_hi:[1,0,1] neg_lo:[1,0,0]
    v_mul_f32 v197, 0x3e000000, v197
    ds_write_addtid_b32 v141 offset:10320
    ds_write_addtid_b32 v142 offset:12384
    ds_write_addtid_b32 v143 offset:14448
    ds_write_addtid_b32 v130 offset:16512
    v_pk_mul_f16 v145, v127, v130 op_sel:[0,0] op_sel_hi:[0,1]
    v_mul_f32 v196, 0x3e000000, v196
    v_pk_fma_f16 v145, v127, v130, v145 op_sel:[1,1,0] op_sel_hi:[1,0,1] neg_lo:[1,0,0]
    v_pk_mul_f16 v146, v128, v130 op_sel:[0,0] op_sel_hi:[0,1]
    v_fract_f32 v205, v197
    v_pk_fma_f16 v146, v128, v130, v146 op_sel:[1,1,0] op_sel_hi:[1,0,1] neg_lo:[1,0,0]
    v_pk_mul_f16 v147, v139, v130 op_sel:[0,0] op_sel_hi:[0,1]
    v_exp_f32 v198, v196
    v_pk_fma_f16 v147, v139, v130, v147 op_sel:[1,1,0] op_sel_hi:[1,0,1] neg_lo:[1,0,0]
    v_pk_mul_f16 v148, v129, v130 op_sel:[0,0] op_sel_hi:[0,1]
    v_cos_f32 v204, v205
    v_pk_fma_f16 v148, v129, v130, v148 op_sel:[1,1,0] op_sel_hi:[1,0,1] neg_lo:[1,0,0]
    ds_write_addtid_b32 v145 offset:18576
    ds_write_addtid_b32 v146 offset:20640
    ds_write_addtid_b32 v147 offset:22704
    ds_write_addtid_b32 v148 offset:24768
    v_pk_mul_f16 v149, v141, v130 op_sel:[0,0] op_sel_hi:[0,1]
    v_sin_f32 v205, v205
    s_waitcnt lgkmcnt(12)
    v_pk_fma_f16 v149, v141, v130, v149 op_sel:[1,1,0] op_sel_hi:[1,0,1] neg_lo:[1,0,0]
    v_pk_mul_f16 v150, v142, v130 op_sel:[0,0] op_sel_hi:[0,1]
    v_pk_fma_f16 v150, v142, v130, v150 op_sel:[1,1,0] op_sel_hi:[1,0,1] neg_lo:[1,0,0]
    v_pk_mul_f16 v151, v143, v130 op_sel:[0,0] op_sel_hi:[0,1]
    v_pk_fma_f16 v151, v143, v130, v151 op_sel:[1,1,0] op_sel_hi:[1,0,1] neg_lo:[1,0,0]
    ds_write_addtid_b32 v149 offset:26832
    ds_write_addtid_b32 v150 offset:28896
    ds_write_addtid_b32 v151 offset:30960
    v_mfma_f32_32x32x16_f16 v[32:47], v[80:83], v[48:51], 0
    v_mul_f32 v204, v204, v198
    v_pk_mul_f16 v228, v127, v131 op_sel:[0,0] op_sel_hi:[0,1]
    v_pk_fma_f16 v228, v127, v131, v228 op_sel:[1,1,0] op_sel_hi:[1,0,1] neg_lo:[1,0,0]
    v_pk_mul_f16 v229, v128, v131 op_sel:[0,0] op_sel_hi:[0,1]
    v_pk_fma_f16 v229, v128, v131, v229 op_sel:[1,1,0] op_sel_hi:[1,0,1] neg_lo:[1,0,0]
    ds_write_addtid_b32 v131 offset:33024
    ds_write_addtid_b32 v228 offset:35088
    v_mfma_f32_32x32x16_f16 v[32:47], v[84:87], v[52:55], v[32:47]
    v_pk_mul_f16 v230, v139, v131 op_sel:[0,0] op_sel_hi:[0,1]
    v_mul_f32 v205, v205, v198
    v_pk_fma_f16 v230, v139, v131, v230 op_sel:[1,1,0] op_sel_hi:[1,0,1] neg_lo:[1,0,0]
    v_pk_mul_f16 v221, v129, v131 op_sel:[0,0] op_sel_hi:[0,1]
    v_pk_fma_f16 v221, v129, v131, v221 op_sel:[1,1,0] op_sel_hi:[1,0,1] neg_lo:[1,0,0]
    ds_write_addtid_b32 v229 offset:37152
    ds_write_addtid_b32 v230 offset:39216
    v_mfma_f32_32x32x16_f16 v[32:47], v[88:91], v[56:59], v[32:47]
    v_pk_mul_f16 v222, v141, v131 op_sel:[0,0] op_sel_hi:[0,1]
    v_pk_fma_f16 v222, v141, v131, v222 op_sel:[1,1,0] op_sel_hi:[1,0,1] neg_lo:[1,0,0]
    v_cvt_pk_f16_f32 v124, v204, v205
    v_pk_mul_f16 v223, v142, v131 op_sel:[0,0] op_sel_hi:[0,1]
    v_pk_fma_f16 v223, v142, v131, v223 op_sel:[1,1,0] op_sel_hi:[1,0,1] neg_lo:[1,0,0]
    ds_write_addtid_b32 v221 offset:41280
    ds_write_addtid_b32 v222 offset:43344
    v_mfma_f32_32x32x16_f16 v[32:47], v[92:95], v[60:63], v[32:47]
    v_pk_mul_f16 v224, v143, v131 op_sel:[0,0] op_sel_hi:[0,1]
    v_pk_fma_f16 v224, v143, v131, v224 op_sel:[1,1,0] op_sel_hi:[1,0,1] neg_lo:[1,0,0]
    v_pk_mul_f16 v225, v130, v131 op_sel:[0,0] op_sel_hi:[0,1]
    v_pk_mul_f16 v125, v124, v124 op_sel:[0,0] op_sel_hi:[0,1]
    v_pk_fma_f16 v225, v130, v131, v225 op_sel:[1,1,0] op_sel_hi:[1,0,1] neg_lo:[1,0,0]
    ds_write_addtid_b32 v223 offset:45408
    ds_write_addtid_b32 v224 offset:47472
    v_mfma_f32_32x32x16_f16 v[32:47], v[96:99], v[64:67], v[32:47]
    v_pk_mul_f16 v226, v145, v131 op_sel:[0,0] op_sel_hi:[0,1]
    v_pk_fma_f16 v226, v145, v131, v226 op_sel:[1,1,0] op_sel_hi:[1,0,1] neg_lo:[1,0,0]
    v_pk_mul_f16 v227, v146, v131 op_sel:[0,0] op_sel_hi:[0,1]
    v_pk_fma_f16 v227, v146, v131, v227 op_sel:[1,1,0] op_sel_hi:[1,0,1] neg_lo:[1,0,0]
    v_pk_fma_f16 v125, v124, v124, v125 op_sel:[1,1,0] op_sel_hi:[1,0,1] neg_lo:[1,0,0]
    ds_write_addtid_b32 v225 offset:49536
    ds_write_addtid_b32 v226 offset:51600
    ds_write_addtid_b32 v227 offset:53664
    v_mfma_f32_32x32x16_f16 v[32:47], v[100:103], v[68:71], v[32:47]
    v_pk_mul_f16 v228, v147, v131 op_sel:[0,0] op_sel_hi:[0,1]
    v_pk_fma_f16 v228, v147, v131, v228 op_sel:[1,1,0] op_sel_hi:[1,0,1] neg_lo:[1,0,0]
    v_pk_mul_f16 v229, v148, v131 op_sel:[0,0] op_sel_hi:[0,1]
    v_pk_fma_f16 v229, v148, v131, v229 op_sel:[1,1,0] op_sel_hi:[1,0,1] neg_lo:[1,0,0]
    v_pk_mul_f16 v230, v149, v131 op_sel:[0,0] op_sel_hi:[0,1]
    ds_write_addtid_b32 v228 offset:55728
    ds_write_addtid_b32 v229 offset:57792
    v_mfma_f32_32x32x16_f16 v[32:47], v[104:107], v[72:75], v[32:47]
    v_pk_fma_f16 v230, v149, v131, v230 op_sel:[1,1,0] op_sel_hi:[1,0,1] neg_lo:[1,0,0]
    v_pk_mul_f16 v126, v125, v125 op_sel:[0,0] op_sel_hi:[0,1]
    v_pk_mul_f16 v221, v150, v131 op_sel:[0,0] op_sel_hi:[0,1]
    v_pk_fma_f16 v221, v150, v131, v221 op_sel:[1,1,0] op_sel_hi:[1,0,1] neg_lo:[1,0,0]
    v_pk_mul_f16 v222, v151, v131 op_sel:[0,0] op_sel_hi:[0,1]
    ds_write_addtid_b32 v230 offset:59856
    ds_write_addtid_b32 v221 offset:61920
    v_mfma_f32_32x32x16_f16 v[32:47], v[108:111], v[76:79], v[32:47]
    v_pk_fma_f16 v222, v151, v131, v222 op_sel:[1,1,0] op_sel_hi:[1,0,1] neg_lo:[1,0,0]
    v_pk_fma_f16 v126, v125, v125, v126 op_sel:[1,1,0] op_sel_hi:[1,0,1] neg_lo:[1,0,0]
    v_cvt_pk_f16_f32 v156, v214, v215
    ds_write_addtid_b32 v222 offset:63984
    s_mov_b32 m0, s52
    v_pk_mul_f16 v157, v156, v124 op_sel:[0,0] op_sel_hi:[0,1] neg_hi:[1,0]
    v_pk_fma_f16 v157, v156, v124, v157 op_sel:[1,1,0] op_sel_hi:[1,0,1]
    v_pk_mul_f16 v158, v156, v125 op_sel:[0,0] op_sel_hi:[0,1] neg_hi:[1,0]
    v_pk_fma_f16 v158, v156, v125, v158 op_sel:[1,1,0] op_sel_hi:[1,0,1]
    ds_write_addtid_b32 v156 offset:0
    ds_read_b128 v[48:51], v9 offset:0
    ds_write_addtid_b32 v157 offset:2064
    ds_read_b128 v[52:55], v9 offset:32
    v_pk_mul_f16 v159, v157, v125 op_sel:[0,0] op_sel_hi:[0,1] neg_hi:[1,0]
    v_pk_fma_f16 v159, v157, v125, v159 op_sel:[1,1,0] op_sel_hi:[1,0,1]
    v_pk_mul_f16 v160, v156, v126 op_sel:[0,0] op_sel_hi:[0,1] neg_hi:[1,0]
    v_pk_fma_f16 v160, v156, v126, v160 op_sel:[1,1,0] op_sel_hi:[1,0,1]
    ds_write_addtid_b32 v158 offset:4128
    ds_write_addtid_b32 v159 offset:6192
    ds_read_b128 v[56:59], v9 offset:64
    ds_write_addtid_b32 v160 offset:8256
    v_pk_mul_f16 v161, v157, v126 op_sel:[0,0] op_sel_hi:[0,1] neg_hi:[1,0]
    v_pk_fma_f16 v161, v157, v126, v161 op_sel:[1,1,0] op_sel_hi:[1,0,1]
    v_pk_mul_f16 v162, v158, v126 op_sel:[0,0] op_sel_hi:[0,1] neg_hi:[1,0]
    v_pk_fma_f16 v162, v158, v126, v162 op_sel:[1,1,0] op_sel_hi:[1,0,1]
    ds_read_b128 v[60:63], v9 offset:96
    ds_write_addtid_b32 v161 offset:10320
    ds_read_b128 v[64:67], v9 offset:128
    ds_write_addtid_b32 v162 offset:12384
    v_pk_mul_f16 v163, v159, v126 op_sel:[0,0] op_sel_hi:[0,1] neg_hi:[1,0]
    v_pk_fma_f16 v163, v159, v126, v163 op_sel:[1,1,0] op_sel_hi:[1,0,1]
    v_pk_mul_f16 v164, v156, v127 op_sel:[0,0] op_sel_hi:[0,1] neg_hi:[1,0]
    v_pk_fma_f16 v164, v156, v127, v164 op_sel:[1,1,0] op_sel_hi:[1,0,1]
    v_pk_mul_f16 v165, v156, v132 op_sel:[0,0] op_sel_hi:[0,1] neg_hi:[1,0]
    ds_write_addtid_b32 v163 offset:14448
    ds_read_b128 v[68:71], v9 offset:160
    ds_write_addtid_b32 v164 offset:24768
    ds_read_b128 v[72:75], v9 offset:192
    v_pk_fma_f16 v165, v156, v132, v165 op_sel:[1,1,0] op_sel_hi:[1,0,1]
    v_pk_mul_f16 v166, v158, v132 op_sel:[0,0] op_sel_hi:[0,1] neg_hi:[1,0]
    v_pk_fma_f16 v166, v158, v132, v166 op_sel:[1,1,0] op_sel_hi:[1,0,1]
    v_pk_mul_f16 v167, v160, v132 op_sel:[0,0] op_sel_hi:[0,1] neg_hi:[1,0]
    v_pk_fma_f16 v167, v160, v132, v167 op_sel:[1,1,0] op_sel_hi:[1,0,1]
    ds_write_addtid_b32 v165 offset:18576
    ds_read_b128 v[76:79], v9 offset:224
    ds_write_addtid_b32 v166 offset:20640
    ds_write_addtid_b32 v167 offset:22704
    v_pk_mul_f16 v168, v162, v132 op_sel:[0,0] op_sel_hi:[0,1] neg_hi:[1,0]
    v_pk_fma_f16 v168, v162, v132, v168 op_sel:[1,1,0] op_sel_hi:[1,0,1]
    v_pk_mul_f16 v169, v164, v132 op_sel:[0,0] op_sel_hi:[0,1] neg_hi:[1,0]
    v_pk_fma_f16 v169, v164, v132, v169 op_sel:[1,1,0] op_sel_hi:[1,0,1]
    v_pk_mul_f16 v170, v160, v133 op_sel:[0,0] op_sel_hi:[0,1] neg_hi:[1,0]
    v_pk_fma_f16 v170, v160, v133, v170 op_sel:[1,1,0] op_sel_hi:[1,0,1]
    v_pk_mul_f16 v171, v164, v133 op_sel:[0,0] op_sel_hi:[0,1] neg_hi:[1,0]
    v_pk_fma_f16 v171, v164, v133, v171 op_sel:[1,1,0] op_sel_hi:[1,0,1]
    ds_write_addtid_b32 v168 offset:28896
    ds_write_addtid_b32 v169 offset:30960
    ds_write_addtid_b32 v170 offset:33024
    ds_write_addtid_b32 v171 offset:35088
    v_pk_mul_f16 v172, v167, v133 op_sel:[0,0] op_sel_hi:[0,1] neg_hi:[1,0]
    v_pk_fma_f16 v172, v167, v133, v172 op_sel:[1,1,0] op_sel_hi:[1,0,1]
    v_pk_mul_f16 v173, v169, v133 op_sel:[0,0] op_sel_hi:[0,1] neg_hi:[1,0]
    v_pk_fma_f16 v173, v169, v133, v173 op_sel:[1,1,0] op_sel_hi:[1,0,1]
    v_pk_mul_f16 v174, v164, v134 op_sel:[0,0] op_sel_hi:[0,1] neg_hi:[1,0]
    v_pk_fma_f16 v174, v164, v134, v174 op_sel:[1,1,0] op_sel_hi:[1,0,1]
    v_pk_mul_f16 v175, v169, v134 op_sel:[0,0] op_sel_hi:[0,1] neg_hi:[1,0]
    v_pk_fma_f16 v175, v169, v134, v175 op_sel:[1,1,0] op_sel_hi:[1,0,1]
    ds_write_addtid_b32 v172 offset:41280
    ds_write_addtid_b32 v173 offset:43344
    ds_write_addtid_b32 v174 offset:37152
    ds_write_addtid_b32 v175 offset:39216
    v_pk_mul_f16 v176, v171, v134 op_sel:[0,0] op_sel_hi:[0,1] neg_hi:[1,0]
    v_pk_fma_f16 v176, v171, v134, v176 op_sel:[1,1,0] op_sel_hi:[1,0,1]
    v_pk_mul_f16 v177, v173, v134 op_sel:[0,0] op_sel_hi:[0,1] neg_hi:[1,0]
    v_pk_fma_f16 v177, v173, v134, v177 op_sel:[1,1,0] op_sel_hi:[1,0,1]
    ds_write_addtid_b32 v176 offset:45408
    ds_write_addtid_b32 v177 offset:47472
    ds_read_b128 v[80:83], v8 offset:0
    ds_read_b128 v[84:87], v8 offset:32
    ds_read_b128 v[88:91], v8 offset:64
    ds_read_b128 v[92:95], v8 offset:96
    ds_read_b128 v[96:99], v8 offset:128
    ds_read_b128 v[100:103], v8 offset:160
    ds_read_b128 v[104:107], v8 offset:192
    ds_read_b128 v[108:111], v8 offset:224
    v_mov_b32 v180, 14336
    v_lshlrev_b32 v180, v3, v180
    v_bfe_u32 v180, v180, v4, 8
    v_lshl_or_b32 v180, v180, 15, v180
    v_and_b32 v181, 65537, v180
    v_mul_u32_u24 v240, 16256, v181
    v_and_b32 v181, 262148, v180
    v_mul_u32_u24 v241, 4064, v181
    v_and_b32 v181, 1048592, v180
    v_mul_u32_u24 v242, 1016, v181
    v_and_b32 v181, 4194368, v180
    v_mul_u32_u24 v243, 254, v181
    v_mov_b32 v180, 8176
    s_waitcnt lgkmcnt(7)
    v_mfma_f32_32x32x16_f16 v[32:47], v[80:83], v[48:51], v[32:47]
    s_waitcnt lgkmcnt(6)
    v_mfma_f32_32x32x16_f16 v[32:47], v[84:87], v[52:55], v[32:47]
    v_lshlrev_b32 v180, v3, v180
    v_bfe_u32 v180, v180, v4, 8
    v_lshl_or_b32 v180, v180, 15, v180
    v_and_b32 v181, 65537, v180
    v_mul_u32_u24 v244, 16256, v181
    s_waitcnt lgkmcnt(5)
    v_mfma_f32_32x32x16_f16 v[32:47], v[88:91], v[56:59], v[32:47]
    v_and_b32 v181, 262148, v180
    v_mul_u32_u24 v245, 4064, v181
    v_and_b32 v181, 1048592, v180
    v_mul_u32_u24 v246, 1016, v181
    v_and_b32 v181, 4194368, v180
    s_waitcnt lgkmcnt(4)
    v_mfma_f32_32x32x16_f16 v[32:47], v[92:95], v[60:63], v[32:47]
    v_mul_u32_u24 v247, 254, v181
    v_mov_b32 v180, 4064
    v_lshlrev_b32 v180, v3, v180
    v_bfe_u32 v180, v180, v4, 8
    v_lshl_or_b32 v180, v180, 15, v180
    s_waitcnt lgkmcnt(3)
    v_mfma_f32_32x32x16_f16 v[32:47], v[96:99], v[64:67], v[32:47]
    v_and_b32 v181, 65537, v180
    v_mul_u32_u24 v248, 16256, v181
    v_and_b32 v181, 262148, v180
    v_mul_u32_u24 v249, 4064, v181
    v_and_b32 v181, 1048592, v180
    s_waitcnt lgkmcnt(2)
    v_mfma_f32_32x32x16_f16 v[32:47], v[100:103], v[68:71], v[32:47]
    s_waitcnt lgkmcnt(0)
    ds_read_b32 v60, v31 offset:32
    ds_read_b128 v[48:51], v20 offset:0
    ds_read_b128 v[52:55], v20 offset:8256
    ds_read_b128 v[56:59], v20 offset:16512
    v_mul_u32_u24 v250, 1016, v181
    v_and_b32 v181, 4194368, v180
    v_mul_u32_u24 v251, 254, v181
    v_mov_b32 v180, 12288
    v_lshlrev_b32 v180, v3, v180
    v_mfma_f32_32x32x16_f16 v[32:47], v[104:107], v[72:75], v[32:47]
    v_bfe_u32 v180, v180, v4, 8
    v_lshl_or_b32 v180, v180, 15, v180
    v_lshrrev_b32 v181, 0, v180
    v_and_b32 v252, 0x10001, v181
    v_lshrrev_b32 v181, 2, v180
    v_mfma_f32_32x32x16_f16 v[32:47], v[108:111], v[76:79], v[32:47]
    v_and_b32 v253, 0x10001, v181
    v_lshrrev_b32 v181, 4, v180
    v_and_b32 v254, 0x10001, v181
    v_lshrrev_b32 v181, 6, v180
    v_and_b32 v255, 0x10001, v181
    s_setprio 2
    s_waitcnt lgkmcnt(3)
    v_cmp_eq_u32 vcc, 0, v60
    s_cbranch_vccnz L_dspin
L_dback:
    s_waitcnt lgkmcnt(2)
    s_nop 1
    v_fma_f32 v48, v32, v19, v48
    v_fma_f32 v49, v33, v19, v49
    v_fma_f32 v50, v34, v19, v50
    v_fma_f32 v51, v35, v19, v51
    s_waitcnt lgkmcnt(1)
    v_fma_f32 v52, v36, v19, v52
    v_fma_f32 v53, v37, v19, v53
    v_fma_f32 v54, v38, v19, v54
    v_fma_f32 v55, v39, v19, v55
    s_waitcnt lgkmcnt(0)
    v_fma_f32 v56, v40, v19, v56
    v_fma_f32 v57, v41, v19, v57
    v_fma_f32 v58, v42, v19, v58
    v_fma_f32 v59, v43, v19, v59
    v_fma_f32 v48, v7, s63, v48
    v_cvt_pk_bf16_f32 v12, v55, v55
    v_cvt_pk_bf16_f32 v11, v49, v48
    v_cvt_pk_bf16_f32 v8, v52, v51
    v_cvt_pk_bf16_f32 v9, v50, v49
    v_cvt_pk_bf16_f32 v10, v51, v50
    v_readlane_b32 s50, v12, 63
    v_readlane_b32 s51, v11, 0
    v_cvt_pk_bf16_f32 v13, v54, v53
    v_cvt_pk_bf16_f32 v14, v55, v54
    v_cvt_pk_bf16_f32 v15, v53, v53
    v_mov_b32 v18, s50
    v_cvt_pk_bf16_f32 v16, v57, v56
    v_writelane_b32 v18, s51, 2
    v_writelane_b32 v18, s51, 8
    v_cvt_pk_bf16_f32 v17, v58, v59
    ds_write_b64 v22, v[8:9] offset:512
    ds_write_b64 v22, v[10:11] offset:4168
    ds_write2_b32 v6, v8, v9 offset0:128 offset1:129
    ds_write2_b32 v27, v10, v11 offset0:128 offset1:129
    ds_write_b64 v22, v[12:13]
    ds_write_b64 v22, v[14:15] offset:3656
    ds_write2_b32 v6, v12, v13 offset0:0 offset1:1
    ds_write2_b32 v27, v14, v15 offset0:0 offset1:1
    ds_write_b16_d16_hi v178, v18
    ds_write_b32 v23, v16
    ds_write_b16 v24, v17 offset:64
    ds_write_b16_d16_hi v24, v17
    ds_read_b64 v[92:93], v26 offset:576
    ds_read_b64 v[94:95], v26 offset:584
    ds_read_b64 v[124:125], v26 offset:64
    ds_read_b64 v[126:127], v26 offset:72
    ds_read_b64 v[88:89], v26 offset:640
    ds_read_b64 v[90:91], v26 offset:648
    ds_read_b64 v[120:121], v26 offset:128
    ds_read_b64 v[122:123], v26 offset:136
    s_waitcnt vmcnt(0)
L_x1waitS:
    ds_read_b32 v30, v0 offset:16
    ds_read_b128 v[48:51], v2 offset:480
    ds_read_b128 v[52:55], v2 offset:464
    ds_read_b128 v[56:59], v2 offset:32
    ds_read_b128 v[60:63], v2 offset:96
    s_waitcnt lgkmcnt(4)
    v_cmp_eq_u32 vcc, 0, v30
    s_cbranch_vccnz L_x1spinS
    s_waitcnt lgkmcnt(3)
    v_mfma_f32_16x16x32_bf16 v[12:15], v[48:51], v[232:235], 0
    ds_read_b64 v[84:85], v26 offset:704
    ds_read_b64 v[86:87], v26 offset:712
    ds_read_b128 v[228:231], v2 offset:160
    v_mfma_f32_16x16x32_bf16 v[16:19], v[48:51], v[236:239], 0
    ds_read_b64 v[116:117], v26 offset:192
    ds_read_b64 v[118:119], v26 offset:200
    ds_read_b64 v[80:81], v26 offset:768
    v_mfma_f32_16x16x32_bf16 v[224:227], v[48:51], v[240:243], 0
    ds_read_b64 v[82:83], v26 offset:776
    ds_read_b64 v[112:113], v26 offset:256
    v_mfma_f32_16x16x32_bf16 v[216:219], v[48:51], v[248:251], 0
    ds_read_b128 v[48:51], v2 offset:224
    ds_read_b64 v[114:115], v26 offset:264
    ds_read_b64 v[76:77], v26 offset:832
    s_waitcnt lgkmcnt(13)
    v_mfma_f32_16x16x32_bf16 v[8:11], v[52:55], v[236:239], 0
    ds_read_b64 v[78:79], v26 offset:840
    v_mfma_f32_16x16x32_bf16 v[220:223], v[52:55], v[244:247], 0
    ds_read_b128 v[52:55], v2 offset:288
    s_waitcnt lgkmcnt(13)
    v_mfma_f32_16x16x32_bf16 v[32:35], v[92:95], v[56:59], 0
    ds_read_b64 v[108:109], v26 offset:320
    ds_read_b64 v[110:111], v26 offset:328
    v_mfma_f32_16x16x32_bf16 v[36:39], v[124:127], v[56:59], 0
    v_mfma_f32_16x16x32_bf16 v[32:35], v[88:91], v[60:63], v[32:35]
    v_cvt_pk_bf16_f32 v173, v16, v224
    v_cvt_pk_bf16_f32 v175, v17, v225
    v_mfma_f32_16x16x32_bf16 v[36:39], v[120:123], v[60:63], v[36:39]
    v_cvt_pk_bf16_f32 v177, v18, v226
    v_cvt_pk_bf16_f32 v179, v19, v227
    s_waitcnt lgkmcnt(4)
    v_mfma_f32_16x16x32_bf16 v[32:35], v[84:87], v[228:231], v[32:35]
    ds_read_b128 v[56:59], v2 offset:992
    ds_read_b128 v[60:63], v2 offset:976
    v_cvt_pk_bf16_f32 v172, v8, v12
    v_cvt_pk_bf16_f32 v174, v9, v13
    v_mfma_f32_16x16x32_bf16 v[36:39], v[116:119], v[228:231], v[36:39]
    ds_read_b64 v[72:73], v26 offset:896
    ds_read_b64 v[74:75], v26 offset:904
    ds_read_b128 v[228:231], v2 offset:352
    v_cvt_pk_bf16_f32 v176, v10, v14
    v_cvt_pk_bf16_f32 v178, v11, v15
    v_mfma_f32_16x16x32_bf16 v[32:35], v[80:83], v[48:51], v[32:35]
    ds_read_b64 v[104:105], v26 offset:384
    ds_read_b64 v[106:107], v26 offset:392
    v_cvt_pk_bf16_f32 v204, v220, v216
    v_cvt_pk_bf16_f32 v205, v221, v217
    v_mfma_f32_16x16x32_bf16 v[36:39], v[112:115], v[48:51], v[36:39]
    ds_read_b64 v[68:69], v26 offset:960
    ds_read_b64 v[70:71], v26 offset:968
    ds_read_b128 v[48:51], v2 offset:416
    v_cvt_pk_bf16_f32 v206, v222, v218
    s_waitcnt lgkmcnt(10)
    v_mfma_f32_16x16x32_bf16 v[32:35], v[76:79], v[52:55], v[32:35]
    ds_read_b64 v[100:101], v26 offset:448
    ds_read_b64 v[102:103], v26 offset:456
    v_cvt_pk_bf16_f32 v207, v223, v219
    v_mfma_f32_16x16x32_bf16 v[36:39], v[108:111], v[52:55], v[36:39]
    ds_read_b64 v[64:65], v26 offset:1024
    ds_read_b64 v[66:67], v26 offset:1032
    ds_read_b128 v[52:55], v2 offset:480
    s_waitcnt lgkmcnt(14)
    v_mfma_f32_16x16x32_bf16 v[164:167], v[56:59], v[232:235], 0
    ds_read_b64 v[96:97], v26 offset:512
    v_mfma_f32_16x16x32_bf16 v[168:171], v[56:59], v[236:239], 0
    v_mfma_f32_16x16x32_bf16 v[4:7], v[56:59], v[240:243], 0
    v_mfma_f32_16x16x32_bf16 v[44:47], v[56:59], v[248:251], 0
    s_waitcnt lgkmcnt(6)
    v_mfma_f32_16x16x32_bf16 v[160:163], v[60:63], v[236:239], 0
    ds_read_b64 v[98:99], v26 offset:520
    ds_read_b64 v[128:129], v26 offset:0
    ds_read_b64 v[130:131], v26 offset:8
    v_mfma_f32_16x16x32_bf16 v[40:43], v[60:63], v[244:247], 0
    ds_read_b128 v[56:59], v2 offset:544
    ds_read_b128 v[60:63], v2 offset:608
    v_mfma_f32_16x16x32_bf16 v[32:35], v[72:75], v[228:231], v[32:35]
    ds_read_u16 v3, v25 offset:4992
    v_mfma_f32_16x16x32_bf16 v[36:39], v[104:107], v[228:231], v[36:39]
    ds_read_b128 v[228:231], v2 offset:672
    v_mfma_f32_16x16x32_bf16 v[32:35], v[68:71], v[48:51], v[32:35]
    v_cvt_pk_bf16_f32 v181, v168, v4
    v_cvt_pk_bf16_f32 v183, v169, v5
    s_waitcnt lgkmcnt(7)
    v_mfma_f32_16x16x32_bf16 v[36:39], v[100:103], v[48:51], v[36:39]
    ds_read_b128 v[48:51], v2 offset:736
    v_cvt_pk_bf16_f32 v185, v170, v6
    v_cvt_pk_bf16_f32 v187, v171, v7
    v_mfma_f32_16x16x32_bf16 v[32:35], v[64:67], v[52:55], v[32:35]
    ds_read_b128 v[4:7], v2 offset:800
    v_cvt_pk_bf16_f32 v180, v160, v164
    v_cvt_pk_bf16_f32 v182, v161, v165
    s_waitcnt lgkmcnt(6)
    v_mfma_f32_16x16x32_bf16 v[36:39], v[96:99], v[52:55], v[36:39]
    v_cvt_pk_bf16_f32 v184, v162, v166
    v_cvt_pk_bf16_f32 v186, v163, v167
    v_cvt_pk_bf16_f32 v208, v40, v44
    v_cvt_pk_bf16_f32 v209, v41, v45
    v_cvt_pk_bf16_f32 v210, v42, v46
    v_cvt_pk_bf16_f32 v211, v43, v47
    v_mfma_f32_16x16x32_bf16 v[40:43], v[128:131], v[52:55], 0
    s_waitcnt lgkmcnt(3)
    v_mfma_f32_16x16x32_bf16 v[36:39], v[92:95], v[56:59], v[36:39]
    ds_read_b128 v[52:55], v2 offset:864
    v_mul_u32_u24 v252, v3, v252
    v_mfma_f32_16x16x32_bf16 v[40:43], v[124:127], v[56:59], v[40:43]
    ds_read_b128 v[56:59], v2 offset:928
    v_mul_u32_u24 v253, v3, v253
    v_mfma_f32_16x16x32_bf16 v[36:39], v[88:91], v[60:63], v[36:39]
    v_mul_u32_u24 v254, v3, v254
    v_mfma_f32_16x16x32_bf16 v[40:43], v[120:123], v[60:63], v[40:43]
    ds_write_b128 v21, v[32:35] offset:0
    s_waitcnt lgkmcnt(3)
    v_mfma_f32_16x16x32_bf16 v[36:39], v[84:87], v[228:231], v[36:39]
    ds_write_b32 v31, v31 offset:64
    ds_read_b128 v[60:63], v2 offset:992
    v_mfma_f32_16x16x32_bf16 v[40:43], v[116:119], v[228:231], v[40:43]
    v_mul_u32_u24 v255, v3, v255
    v_mfma_f32_16x16x32_bf16 v[36:39], v[80:83], v[48:51], v[36:39]
    ds_read_b64 v[132:133], v28 offset:256
    v_mfma_f32_16x16x32_bf16 v[40:43], v[112:115], v[48:51], v[40:43]
    ds_read_b64 v[134:135], v28 offset:264
    v_mfma_f32_16x16x32_bf16 v[36:39], v[76:79], v[4:7], v[36:39]
    ds_read_b64 v[136:137], v28 offset:272
    v_mfma_f32_16x16x32_bf16 v[40:43], v[108:111], v[4:7], v[40:43]
    ds_read_b64 v[138:139], v28 offset:280
    s_waitcnt lgkmcnt(6)
    v_mfma_f32_16x16x32_bf16 v[36:39], v[72:75], v[52:55], v[36:39]
    ds_read_b128 v[228:231], v2 offset:1056
    v_mfma_f32_16x16x32_bf16 v[40:43], v[104:107], v[52:55], v[40:43]
    ds_read_b128 v[24:27], v2 offset:1120
    v_mfma_f32_16x16x32_bf16 v[36:39], v[68:71], v[56:59], v[36:39]
    ds_read_b128 v[48:51], v2 offset:1184
    v_mfma_f32_16x16x32_bf16 v[40:43], v[100:103], v[56:59], v[40:43]
    s_waitcnt lgkmcnt(5)
    v_mfma_f32_16x16x32_bf16 v[36:39], v[64:67], v[60:63], v[36:39]
    ds_read_b128 v[4:7], v2 offset:1248
    v_mfma_f32_16x16x32_bf16 v[40:43], v[96:99], v[60:63], v[40:43]
    v_mfma_f32_16x16x32_bf16 v[44:47], v[128:131], v[60:63], 0
    ds_read_b128 v[52:55], v2 offset:1312
    v_mfma_f32_16x16x32_bf16 v[40:43], v[172:175], v[132:135], v[40:43]
    s_waitcnt lgkmcnt(3)
    v_mfma_f32_16x16x32_bf16 v[40:43], v[176:179], v[136:139], v[40:43]
    ds_read_b128 v[56:59], v2 offset:1376
    v_mfma_f32_16x16x32_bf16 v[40:43], v[92:95], v[228:231], v[40:43]
    v_mfma_f32_16x16x32_bf16 v[44:47], v[124:127], v[228:231], v[44:47]
    ds_write_b128 v21, v[36:39] offset:2064
    v_mfma_f32_16x16x32_bf16 v[40:43], v[88:91], v[24:27], v[40:43]
    ds_write_b32 v31, v31 offset:80
    ds_read_b128 v[60:63], v2 offset:1440
    v_mfma_f32_16x16x32_bf16 v[44:47], v[120:123], v[24:27], v[44:47]
    ds_read_b128 v[228:231], v2 offset:1504
    s_waitcnt lgkmcnt(5)
    v_mfma_f32_16x16x32_bf16 v[40:43], v[84:87], v[48:51], v[40:43]
    v_mfma_f32_16x16x32_bf16 v[44:47], v[116:119], v[48:51], v[44:47]
    v_mfma_f32_16x16x32_bf16 v[40:43], v[80:83], v[4:7], v[40:43]
    v_mfma_f32_16x16x32_bf16 v[44:47], v[112:115], v[4:7], v[44:47]
    v_mfma_f32_16x16x32_bf16 v[40:43], v[76:79], v[52:55], v[40:43]
    v_mfma_f32_16x16x32_bf16 v[44:47], v[108:111], v[52:55], v[44:47]
    s_waitcnt lgkmcnt(0)
    v_mfma_f32_16x16x32_bf16 v[40:43], v[72:75], v[56:59], v[40:43]
    ds_read_b128 v[24:27], v2 offset:1488
    v_mfma_f32_16x16x32_bf16 v[44:47], v[104:107], v[56:59], v[44:47]
    v_mfma_f32_16x16x32_bf16 v[40:43], v[68:71], v[60:63], v[40:43]
    ds_read_b64 v[140:141], v28 offset:128
    v_mfma_f32_16x16x32_bf16 v[44:47], v[100:103], v[60:63], v[44:47]
    ds_read_b64 v[142:143], v28 offset:136
    v_mfma_f32_16x16x32_bf16 v[40:43], v[64:67], v[228:231], v[40:43]
    ds_read_b64 v[144:145], v28 offset:144
    v_mfma_f32_16x16x32_bf16 v[44:47], v[96:99], v[228:231], v[44:47]
    ds_read_b64 v[146:147], v28 offset:152
    v_mfma_f32_16x16x32_bf16 v[32:35], v[128:131], v[228:231], 0
    ds_read_b128 v[48:51], v2 offset:1568
    v_mfma_f32_16x16x32_bf16 v[12:15], v[228:231], v[232:235], 0
    v_mfma_f32_16x16x32_bf16 v[16:19], v[228:231], v[236:239], 0
    ds_read_b128 v[4:7], v2 offset:1632
    v_mfma_f32_16x16x32_bf16 v[224:227], v[228:231], v[240:243], 0
    v_mfma_f32_16x16x32_bf16 v[216:219], v[228:231], v[248:251], 0
    ds_write_b128 v21, v[40:43] offset:4128
    s_waitcnt lgkmcnt(4)
    v_mfma_f32_16x16x32_bf16 v[8:11], v[24:27], v[236:239], 0
    ds_write_b32 v31, v31 offset:96
    ds_read_b128 v[52:55], v2 offset:1696
    v_mfma_f32_16x16x32_bf16 v[220:223], v[24:27], v[244:247], 0
    ds_read_b128 v[56:59], v2 offset:1760
    v_mfma_f32_16x16x32_bf16 v[44:47], v[172:175], v[140:143], v[44:47]
    s_waitcnt lgkmcnt(5)
    v_mfma_f32_16x16x32_bf16 v[44:47], v[176:179], v[144:147], v[44:47]
    ds_read_b128 v[60:63], v2 offset:1824
    v_mfma_f32_16x16x32_bf16 v[44:47], v[180:183], v[132:135], v[44:47]
    v_cvt_pk_bf16_f32 v189, v16, v224
    v_cvt_pk_bf16_f32 v191, v17, v225
    v_mfma_f32_16x16x32_bf16 v[44:47], v[184:187], v[136:139], v[44:47]
    ds_read_b128 v[228:231], v2 offset:1888
    v_cvt_pk_bf16_f32 v193, v18, v226
    v_mfma_f32_16x16x32_bf16 v[44:47], v[92:95], v[48:51], v[44:47]
    v_cvt_pk_bf16_f32 v195, v19, v227
    v_cvt_pk_bf16_f32 v188, v8, v12
    v_mfma_f32_16x16x32_bf16 v[32:35], v[124:127], v[48:51], v[32:35]
    ds_read_b128 v[24:27], v2 offset:1952
    s_waitcnt lgkmcnt(3)
    v_mfma_f32_16x16x32_bf16 v[44:47], v[88:91], v[4:7], v[44:47]
    v_cvt_pk_bf16_f32 v190, v9, v13
    v_cvt_pk_bf16_f32 v192, v10, v14
    v_mfma_f32_16x16x32_bf16 v[32:35], v[120:123], v[4:7], v[32:35]
    ds_read_b128 v[48:51], v2 offset:2016
    v_cvt_pk_bf16_f32 v194, v11, v15
    v_mfma_f32_16x16x32_bf16 v[44:47], v[84:87], v[52:55], v[44:47]
    v_cvt_pk_bf16_f32 v212, v220, v216
    v_cvt_pk_bf16_f32 v213, v221, v217
    v_mfma_f32_16x16x32_bf16 v[32:35], v[116:119], v[52:55], v[32:35]
    v_cvt_pk_bf16_f32 v214, v222, v218
    v_cvt_pk_bf16_f32 v215, v223, v219
    v_mfma_f32_16x16x32_bf16 v[44:47], v[80:83], v[56:59], v[44:47]
    ds_read_b64 v[148:149], v28 offset:0
    v_mfma_f32_16x16x32_bf16 v[32:35], v[112:115], v[56:59], v[32:35]
    ds_read_b64 v[150:151], v28 offset:8
    s_waitcnt lgkmcnt(3)
    v_mfma_f32_16x16x32_bf16 v[44:47], v[76:79], v[60:63], v[44:47]
    ds_read_b32 v30, v0 offset:16
    ds_read_b64 v[152:153], v28 offset:16
    v_mfma_f32_16x16x32_bf16 v[32:35], v[108:111], v[60:63], v[32:35]
    ds_read_b64 v[154:155], v28 offset:24
    v_mfma_f32_16x16x32_bf16 v[44:47], v[72:75], v[228:231], v[44:47]
    v_mfma_f32_16x16x32_bf16 v[32:35], v[104:107], v[228:231], v[32:35]
    v_mfma_f32_16x16x32_bf16 v[44:47], v[68:71], v[24:27], v[44:47]
    ds_read2_b32 v[156:157], v29 offset0:48 offset1:49
    v_mfma_f32_16x16x32_bf16 v[32:35], v[100:103], v[24:27], v[32:35]
    ds_read2_b32 v[158:159], v29 offset0:50 offset1:51
    s_waitcnt lgkmcnt(5)
    v_mfma_f32_16x16x32_bf16 v[44:47], v[64:67], v[48:51], v[44:47]
    s_waitcnt lgkmcnt(3)
    v_cmp_gt_u32 vcc, 2, v30
    v_mfma_f32_16x16x32_bf16 v[32:35], v[96:99], v[48:51], v[32:35]
    s_cbranch_vccnz L_xspinS2
L_xbackS2:
    ds_read_b128 v[4:7], v2 offset:480
    v_mfma_f32_16x16x32_bf16 v[36:39], v[128:131], v[48:51], 0
    ds_read_b128 v[52:55], v2 offset:2080
    v_mfma_f32_16x16x32_bf16 v[32:35], v[172:175], v[148:151], v[32:35]
    ds_read_b128 v[56:59], v2 offset:2144
    s_waitcnt lgkmcnt(5)
    v_mfma_f32_16x16x32_bf16 v[32:35], v[176:179], v[152:155], v[32:35]
    ds_read_b128 v[60:63], v2 offset:2208
    v_mfma_f32_16x16x32_bf16 v[32:35], v[180:183], v[140:143], v[32:35]
    ds_read_b128 v[228:231], v2 offset:2272
    v_mfma_f32_16x16x32_bf16 v[32:35], v[184:187], v[144:147], v[32:35]
    ds_write_b128 v21, v[44:47] offset:6192
    v_mfma_f32_16x16x32_bf16 v[32:35], v[188:191], v[132:135], v[32:35]
    ds_write_b32 v31, v31 offset:112
    ds_read_b128 v[24:27], v2 offset:2336
    v_mfma_f32_16x16x32_bf16 v[32:35], v[192:195], v[136:139], v[32:35]
    ds_read_b128 v[48:51], v2 offset:2400
    s_waitcnt lgkmcnt(7)
    v_mfma_f32_16x16x32_bf16 v[32:35], v[204:207], v[156:159], v[32:35]
    v_mfma_f32_16x16x32_bf16 v[32:35], v[252:255], v[4:7], v[32:35]
    ds_read_b128 v[4:7], v2 offset:2464
    v_mfma_f32_16x16x32_bf16 v[32:35], v[92:95], v[52:55], v[32:35]
    ds_read_b128 v[52:55], v2 offset:2528
    s_waitcnt lgkmcnt(6)
    v_mfma_f32_16x16x32_bf16 v[32:35], v[88:91], v[56:59], v[32:35]
    ds_read_b128 v[56:59], v2 offset:2016
    v_mfma_f32_16x16x32_bf16 v[32:35], v[84:87], v[60:63], v[32:35]
    v_mfma_f32_16x16x32_bf16 v[32:35], v[80:83], v[228:231], v[32:35]
    ds_read_b128 v[60:63], v2 offset:2000
    s_waitcnt lgkmcnt(4)
    v_mfma_f32_16x16x32_bf16 v[32:35], v[76:79], v[24:27], v[32:35]
    v_mfma_f32_16x16x32_bf16 v[32:35], v[72:75], v[48:51], v[32:35]
    s_waitcnt lgkmcnt(3)
    v_mfma_f32_16x16x32_bf16 v[32:35], v[68:71], v[4:7], v[32:35]
    s_waitcnt lgkmcnt(2)
    v_mfma_f32_16x16x32_bf16 v[32:35], v[64:67], v[52:55], v[32:35]
    v_mfma_f32_16x16x32_bf16 v[36:39], v[96:99], v[52:55], v[36:39]
    v_mfma_f32_16x16x32_bf16 v[40:43], v[128:131], v[52:55], 0
    ds_read2_b32 v[160:161], v29 offset0:32 offset1:33
    s_waitcnt lgkmcnt(1)
    v_mfma_f32_16x16x32_bf16 v[12:15], v[56:59], v[232:235], 0
    ds_read2_b32 v[162:163], v29 offset0:34 offset1:35
    v_mfma_f32_16x16x32_bf16 v[16:19], v[56:59], v[236:239], 0
    ds_read_b128 v[228:231], v2 offset:992
    v_mfma_f32_16x16x32_bf16 v[224:227], v[56:59], v[240:243], 0
    ds_read_b128 v[24:27], v2 offset:2080
    v_mfma_f32_16x16x32_bf16 v[216:219], v[56:59], v[248:251], 0
    ds_write_b128 v21, v[32:35] offset:33024
    v_mfma_f32_16x16x32_bf16 v[8:11], v[60:63], v[236:239], 0
    ds_write_b32 v31, v31 offset:128
    ds_read_b128 v[48:51], v2 offset:2144
    v_mfma_f32_16x16x32_bf16 v[220:223], v[60:63], v[244:247], 0
    ds_read_b128 v[4:7], v2 offset:2208
    v_mfma_f32_16x16x32_bf16 v[36:39], v[180:183], v[148:151], v[36:39]
    ds_read_b128 v[52:55], v2 offset:2272
    v_mfma_f32_16x16x32_bf16 v[36:39], v[184:187], v[152:155], v[36:39]
    ds_read_b128 v[56:59], v2 offset:2336
    v_mfma_f32_16x16x32_bf16 v[36:39], v[188:191], v[140:143], v[36:39]
    ds_read_b128 v[60:63], v2 offset:2400
    v_cvt_pk_bf16_f32 v197, v16, v224
    v_mfma_f32_16x16x32_bf16 v[36:39], v[192:195], v[144:147], v[36:39]
    v_cvt_pk_bf16_f32 v199, v17, v225
    s_waitcnt lgkmcnt(6)
    v_mfma_f32_16x16x32_bf16 v[36:39], v[204:207], v[160:163], v[36:39]
    v_cvt_pk_bf16_f32 v201, v18, v226
    v_cvt_pk_bf16_f32 v203, v19, v227
    v_mfma_f32_16x16x32_bf16 v[36:39], v[208:211], v[156:159], v[36:39]
    v_cvt_pk_bf16_f32 v196, v8, v12
    v_cvt_pk_bf16_f32 v198, v9, v13
    v_mfma_f32_16x16x32_bf16 v[36:39], v[252:255], v[228:231], v[36:39]
    ds_read_b128 v[228:231], v2 offset:2464
    v_cvt_pk_bf16_f32 v200, v10, v14
    v_mfma_f32_16x16x32_bf16 v[36:39], v[124:127], v[24:27], v[36:39]
    ds_read_b128 v[24:27], v2 offset:2592
    s_waitcnt lgkmcnt(3)
    v_mfma_f32_16x16x32_bf16 v[36:39], v[120:123], v[48:51], v[36:39]
    ds_read_b128 v[48:51], v2 offset:2656
    v_cvt_pk_bf16_f32 v202, v11, v15
    v_mfma_f32_16x16x32_bf16 v[36:39], v[116:119], v[4:7], v[36:39]
    ds_read_b128 v[4:7], v2 offset:2720
    v_cvt_pk_bf16_f32 v216, v220, v216
    v_mfma_f32_16x16x32_bf16 v[36:39], v[112:115], v[52:55], v[36:39]
    ds_read_b128 v[52:55], v2 offset:2784
    v_cvt_pk_bf16_f32 v217, v221, v217
    v_mfma_f32_16x16x32_bf16 v[36:39], v[108:111], v[56:59], v[36:39]
    ds_read_b128 v[56:59], v2 offset:2848
    s_waitcnt lgkmcnt(6)
    v_mfma_f32_16x16x32_bf16 v[36:39], v[104:107], v[60:63], v[36:39]
    ds_read_b128 v[60:63], v2 offset:2912
    s_waitcnt lgkmcnt(6)
    v_mfma_f32_16x16x32_bf16 v[36:39], v[100:103], v[228:231], v[36:39]
    ds_read_b128 v[228:231], v2 offset:2976
    s_waitcnt lgkmcnt(6)
    v_mfma_f32_16x16x32_bf16 v[36:39], v[92:95], v[24:27], v[36:39]
    ds_read_b128 v[24:27], v2 offset:3040
    s_waitcnt lgkmcnt(6)
    v_mfma_f32_16x16x32_bf16 v[36:39], v[88:91], v[48:51], v[36:39]
    ds_read_b128 v[48:51], v2 offset:2528
    s_waitcnt lgkmcnt(6)
    v_mfma_f32_16x16x32_bf16 v[36:39], v[84:87], v[4:7], v[36:39]
    v_cvt_pk_bf16_f32 v218, v222, v218
    s_waitcnt lgkmcnt(5)
    v_mfma_f32_16x16x32_bf16 v[36:39], v[80:83], v[52:55], v[36:39]
    v_cvt_pk_bf16_f32 v219, v223, v219
    s_waitcnt lgkmcnt(4)
    v_mfma_f32_16x16x32_bf16 v[36:39], v[76:79], v[56:59], v[36:39]
    ds_read_b128 v[4:7], v2 offset:2512
    v_mfma_f32_16x16x32_bf16 v[36:39], v[196:199], v[132:135], v[36:39]
    v_mfma_f32_16x16x32_bf16 v[36:39], v[200:203], v[136:139], v[36:39]
    s_waitcnt lgkmcnt(2)
    v_mfma_f32_16x16x32_bf16 v[36:39], v[72:75], v[60:63], v[36:39]
    v_mfma_f32_16x16x32_bf16 v[36:39], v[68:71], v[228:231], v[36:39]
    v_mfma_f32_16x16x32_bf16 v[36:39], v[64:67], v[24:27], v[36:39]
    ds_read2_b32 v[164:165], v29 offset0:16 offset1:17
    v_mfma_f32_16x16x32_bf16 v[40:43], v[96:99], v[24:27], v[40:43]
    ds_read2_b32 v[166:167], v29 offset0:18 offset1:19
    v_mfma_f32_16x16x32_bf16 v[44:47], v[128:131], v[24:27], 0
    s_waitcnt lgkmcnt(2)
    v_mfma_f32_16x16x32_bf16 v[12:15], v[48:51], v[232:235], 0
    ds_read_b128 v[52:55], v2 offset:1504
    v_mfma_f32_16x16x32_bf16 v[16:19], v[48:51], v[236:239], 0
    ds_read_b128 v[56:59], v2 offset:2592
    v_mfma_f32_16x16x32_bf16 v[224:227], v[48:51], v[240:243], 0
    ds_read_b128 v[220:223], v2 offset:2656
    v_mfma_f32_16x16x32_bf16 v[8:11], v[4:7], v[236:239], 0
    ds_write_b128 v21, v[36:39] offset:35088
    v_mfma_f32_16x16x32_bf16 v[40:43], v[188:191], v[148:151], v[40:43]
    ds_write_b32 v31, v31 offset:144
    ds_read_b128 v[60:63], v2 offset:2720
    v_mfma_f32_16x16x32_bf16 v[40:43], v[192:195], v[152:155], v[40:43]
    ds_read_b128 v[228:231], v2 offset:2784
    v_mfma_f32_16x16x32_bf16 v[40:43], v[196:199], v[140:143], v[40:43]
    ds_read_b128 v[24:27], v2 offset:2848
    v_cvt_pk_bf16_f32 v173, v16, v224
    v_mfma_f32_16x16x32_bf16 v[40:43], v[200:203], v[144:147], v[40:43]
    ds_read_b128 v[48:51], v2 offset:2912
    s_waitcnt lgkmcnt(7)
    v_mfma_f32_16x16x32_bf16 v[40:43], v[204:207], v[164:167], v[40:43]
    ds_read_b128 v[4:7], v2 offset:2976
    v_cvt_pk_bf16_f32 v175, v17, v225
    v_mfma_f32_16x16x32_bf16 v[40:43], v[208:211], v[160:163], v[40:43]
    v_cvt_pk_bf16_f32 v177, v18, v226
    v_cvt_pk_bf16_f32 v179, v19, v227
    v_mfma_f32_16x16x32_bf16 v[40:43], v[212:215], v[156:159], v[40:43]
    v_cvt_pk_bf16_f32 v172, v8, v12
    v_cvt_pk_bf16_f32 v174, v9, v13
    v_mfma_f32_16x16x32_bf16 v[40:43], v[252:255], v[52:55], v[40:43]
    ds_read_b128 v[52:55], v2 offset:3104
    v_cvt_pk_bf16_f32 v176, v10, v14
    v_mfma_f32_16x16x32_bf16 v[40:43], v[124:127], v[56:59], v[40:43]
    ds_read_b128 v[56:59], v2 offset:3168
    s_waitcnt lgkmcnt(4)
    v_mfma_f32_16x16x32_bf16 v[40:43], v[120:123], v[220:223], v[40:43]
    ds_read_b128 v[220:223], v2 offset:3232
    v_cvt_pk_bf16_f32 v178, v11, v15
    v_mfma_f32_16x16x32_bf16 v[40:43], v[116:119], v[60:63], v[40:43]
    ds_read_b128 v[60:63], v2 offset:3296
    v_mfma_f32_16x16x32_bf16 v[40:43], v[112:115], v[228:231], v[40:43]
    ds_read_b128 v[228:231], v2 offset:3360
    v_mfma_f32_16x16x32_bf16 v[40:43], v[108:111], v[24:27], v[40:43]
    ds_read_b128 v[24:27], v2 offset:3424
    s_waitcnt lgkmcnt(6)
    v_mfma_f32_16x16x32_bf16 v[40:43], v[104:107], v[48:51], v[40:43]
    ds_read_b128 v[48:51], v2 offset:3488
    v_mfma_f32_16x16x32_bf16 v[40:43], v[100:103], v[4:7], v[40:43]
    ds_read_b128 v[4:7], v2 offset:3552
    s_waitcnt lgkmcnt(6)
    v_mfma_f32_16x16x32_bf16 v[40:43], v[92:95], v[52:55], v[40:43]
    ds_read_b128 v[52:55], v2 offset:3040
    v_mfma_f32_16x16x32_bf16 v[40:43], v[88:91], v[56:59], v[40:43]
    s_waitcnt lgkmcnt(5)
    v_mfma_f32_16x16x32_bf16 v[40:43], v[84:87], v[220:223], v[40:43]
    v_mfma_f32_16x16x32_bf16 v[40:43], v[80:83], v[60:63], v[40:43]
    ds_read_b128 v[56:59], v2 offset:3024
    s_waitcnt lgkmcnt(4)
    v_mfma_f32_16x16x32_bf16 v[40:43], v[76:79], v[228:231], v[40:43]
    v_mfma_f32_16x16x32_bf16 v[40:43], v[172:175], v[132:135], v[40:43]
    v_mfma_f32_16x16x32_bf16 v[40:43], v[176:179], v[136:139], v[40:43]
    v_mfma_f32_16x16x32_bf16 v[40:43], v[72:75], v[24:27], v[40:43]
    s_waitcnt lgkmcnt(1)
    v_mfma_f32_16x16x32_bf16 v[40:43], v[68:71], v[48:51], v[40:43]
    ds_read2_b32 v[168:169], v29 offset0:0 offset1:1
    v_mfma_f32_16x16x32_bf16 v[40:43], v[64:67], v[4:7], v[40:43]
    ds_read2_b32 v[170:171], v29 offset0:2 offset1:3
    v_mfma_f32_16x16x32_bf16 v[44:47], v[96:99], v[4:7], v[44:47]
    v_mfma_f32_16x16x32_bf16 v[12:15], v[52:55], v[232:235], 0
    v_mfma_f32_16x16x32_bf16 v[16:19], v[52:55], v[236:239], 0
    ds_read_b128 v[220:223], v2 offset:2016
    v_mfma_f32_16x16x32_bf16 v[224:227], v[52:55], v[240:243], 0
    ds_read_b128 v[60:63], v2 offset:3104
    s_waitcnt lgkmcnt(4)
    v_mfma_f32_16x16x32_bf16 v[8:11], v[56:59], v[236:239], 0
    ds_write_b128 v21, v[40:43] offset:37152
    v_mfma_f32_16x16x32_bf16 v[44:47], v[196:199], v[148:151], v[44:47]
    ds_write_b32 v31, v31 offset:160
    ds_read_b128 v[228:231], v2 offset:3168
    v_mfma_f32_16x16x32_bf16 v[44:47], v[200:203], v[152:155], v[44:47]
    ds_read_b128 v[24:27], v2 offset:3232
    v_mfma_f32_16x16x32_bf16 v[44:47], v[172:175], v[140:143], v[44:47]
    ds_read_b128 v[48:51], v2 offset:3296
    v_cvt_pk_bf16_f32 v181, v16, v224
    v_mfma_f32_16x16x32_bf16 v[44:47], v[176:179], v[144:147], v[44:47]
    ds_read_b128 v[4:7], v2 offset:3360
    s_waitcnt lgkmcnt(7)
    v_mfma_f32_16x16x32_bf16 v[44:47], v[204:207], v[168:171], v[44:47]
    ds_read_b128 v[52:55], v2 offset:3424
    v_cvt_pk_bf16_f32 v183, v17, v225
    v_mfma_f32_16x16x32_bf16 v[44:47], v[208:211], v[164:167], v[44:47]
    ds_read_b128 v[56:59], v2 offset:3488
    v_cvt_pk_bf16_f32 v185, v18, v226
    v_mfma_f32_16x16x32_bf16 v[44:47], v[212:215], v[160:163], v[44:47]
    v_cvt_pk_bf16_f32 v187, v19, v227
    v_cvt_pk_bf16_f32 v180, v8, v12
    v_mfma_f32_16x16x32_bf16 v[44:47], v[216:219], v[156:159], v[44:47]
    v_cvt_pk_bf16_f32 v182, v9, v13
    v_cvt_pk_bf16_f32 v184, v10, v14
    v_mfma_f32_16x16x32_bf16 v[44:47], v[252:255], v[220:223], v[44:47]
    ds_read_b128 v[220:223], v2 offset:3616
    s_waitcnt lgkmcnt(4)
    v_mfma_f32_16x16x32_bf16 v[44:47], v[124:127], v[60:63], v[44:47]
    ds_read_b128 v[60:63], v2 offset:3680
    v_cvt_pk_bf16_f32 v186, v11, v15
    v_mfma_f32_16x16x32_bf16 v[44:47], v[120:123], v[228:231], v[44:47]
    ds_read_b128 v[228:231], v2 offset:3744
    v_mfma_f32_16x16x32_bf16 v[44:47], v[116:119], v[24:27], v[44:47]
    ds_read_b128 v[24:27], v2 offset:3808
    v_mfma_f32_16x16x32_bf16 v[44:47], v[112:115], v[48:51], v[44:47]
    ds_read_b128 v[48:51], v2 offset:3872
    s_waitcnt lgkmcnt(5)
    v_mfma_f32_16x16x32_bf16 v[44:47], v[108:111], v[4:7], v[44:47]
    ds_read_b128 v[4:7], v2 offset:3936
    v_mfma_f32_16x16x32_bf16 v[44:47], v[104:107], v[52:55], v[44:47]
    ds_read_b128 v[52:55], v2 offset:4000
    v_mfma_f32_16x16x32_bf16 v[44:47], v[100:103], v[56:59], v[44:47]
    ds_read_b128 v[56:59], v2 offset:4064
    s_waitcnt lgkmcnt(6)
    v_mfma_f32_16x16x32_bf16 v[44:47], v[92:95], v[220:223], v[44:47]
    v_mfma_f32_16x16x32_bf16 v[44:47], v[88:91], v[60:63], v[44:47]
    s_waitcnt lgkmcnt(4)
    v_mfma_f32_16x16x32_bf16 v[44:47], v[84:87], v[228:231], v[44:47]
    v_mfma_f32_16x16x32_bf16 v[44:47], v[80:83], v[24:27], v[44:47]
    s_waitcnt lgkmcnt(2)
    v_mfma_f32_16x16x32_bf16 v[44:47], v[76:79], v[48:51], v[44:47]
    v_mfma_f32_16x16x32_bf16 v[44:47], v[180:183], v[132:135], v[44:47]
    v_mfma_f32_16x16x32_bf16 v[44:47], v[184:187], v[136:139], v[44:47]
    v_mfma_f32_16x16x32_bf16 v[44:47], v[72:75], v[4:7], v[44:47]
    s_waitcnt lgkmcnt(0)
    v_mfma_f32_16x16x32_bf16 v[44:47], v[68:71], v[52:55], v[44:47]
    v_mfma_f32_16x16x32_bf16 v[44:47], v[64:67], v[56:59], v[44:47]
    s_nop 7
    ds_write_b128 v21, v[44:47] offset:39216
    ds_write_b32 v31, v31 offset:176
    s_branch L_exit
L_x1spinS:
    ds_read_b32 v30, v0 offset:16
    s_waitcnt lgkmcnt(0)
    v_cmp_eq_u32 vcc, 0, v30
    s_cbranch_vccnz L_x1spinS
    s_branch L_x1waitS
L_xspinS2:
    ds_read_b32 v30, v0 offset:16
    s_waitcnt lgkmcnt(0)
    v_cmp_gt_u32 vcc, 2, v30
    s_cbranch_vccnz L_xspinS2
    s_branch L_xbackS2
L_dspin:
    ds_read_b32 v60, v31 offset:32
    s_waitcnt lgkmcnt(0)
    v_cmp_eq_u32 vcc, 0, v60
    s_cbranch_vccnz L_dspin
    ds_read_b128 v[48:51], v20
    ds_read_b128 v[52:55], v20 offset:8256
    ds_read_b128 v[56:59], v20 offset:16512
    s_branch L_dback
L_helper:
    s_waitcnt vmcnt(4)
    v_lshlrev_b32 v183, 16, v11
    v_lshlrev_b32 v180, 16, v10
    v_mul_f32 v181, v183, v17
    v_mul_f32 v180, v180, v16
    v_fma_f32 v182, v183, v17, -v181
    v_fract_f32 v185, v181
    v_fma_f32 v182, v183, v18, v182
    v_exp_f32 v183, v180
    v_add_f32 v185, v185, v182
    v_cos_f32 v184, v185
    v_sin_f32 v185, v185
    v_mul_f32 v184, v184, v183
    v_mul_f32 v185, v185, v183
    v_cvt_pk_f16_f32 v115, v184, v185
    s_mov_b32 m0, s53
    v_mul_f32 v186, v185, v185
    v_mul_f32 v181, 0x3e000000, v181
    v_mul_f32 v187, v184, v185 mul:2
    v_fma_f32 v186, v184, v184, -v186
    v_mul_f32 v180, 0x3e000000, v180
    v_cvt_pk_f16_f32 v116, v186, v187
    v_fract_f32 v189, v181
    v_pk_mul_f16 v139, v115, v116 op_sel:[0,0] op_sel_hi:[0,1]
    v_pk_fma_f16 v139, v115, v116, v139 op_sel:[1,1,0] op_sel_hi:[1,0,1] neg_lo:[1,0,0]
    v_exp_f32 v182, v180
    v_mul_f32 v184, v187, v187
    v_mul_f32 v185, v186, v187 mul:2
    v_cos_f32 v188, v189
    v_fma_f32 v184, v186, v186, -v184
    v_cvt_pk_f16_f32 v117, v184, v185
    v_sin_f32 v189, v189
    ds_write_addtid_b32 v115 offset:2064
    ds_write_addtid_b32 v116 offset:4128
    ds_write_addtid_b32 v139 offset:6192
    ds_write_addtid_b32 v117 offset:8256
    v_pk_mul_f16 v141, v115, v117 op_sel:[0,0] op_sel_hi:[0,1]
    v_mul_f32 v188, v188, v182
    v_pk_fma_f16 v141, v115, v117, v141 op_sel:[1,1,0] op_sel_hi:[1,0,1] neg_lo:[1,0,0]
    v_pk_mul_f16 v142, v116, v117 op_sel:[0,0] op_sel_hi:[0,1]
    v_mul_f32 v189, v189, v182
    v_pk_fma_f16 v142, v116, v117, v142 op_sel:[1,1,0] op_sel_hi:[1,0,1] neg_lo:[1,0,0]
    v_cvt_pk_f16_f32 v112, v188, v189
    v_pk_mul_f16 v143, v139, v117 op_sel:[0,0] op_sel_hi:[0,1]
    v_pk_fma_f16 v143, v139, v117, v143 op_sel:[1,1,0] op_sel_hi:[1,0,1] neg_lo:[1,0,0]
    v_pk_mul_f16 v113, v112, v112 op_sel:[0,0] op_sel_hi:[0,1]
    v_mul_f32 v186, v185, v185
    v_pk_fma_f16 v113, v112, v112, v113 op_sel:[1,1,0] op_sel_hi:[1,0,1] neg_lo:[1,0,0]
    v_mul_f32 v187, v184, v185 mul:2
    v_fma_f32 v186, v184, v184, -v186
    v_cvt_pk_f16_f32 v118, v186, v187
    v_pk_mul_f16 v114, v113, v113 op_sel:[0,0] op_sel_hi:[0,1]
    ds_write_addtid_b32 v141 offset:10320
    ds_write_addtid_b32 v142 offset:12384
    ds_write_addtid_b32 v143 offset:14448
    ds_write_addtid_b32 v118 offset:16512
    v_pk_mul_f16 v145, v115, v118 op_sel:[0,0] op_sel_hi:[0,1]
    v_pk_fma_f16 v114, v113, v113, v114 op_sel:[1,1,0] op_sel_hi:[1,0,1] neg_lo:[1,0,0]
    v_pk_fma_f16 v145, v115, v118, v145 op_sel:[1,1,0] op_sel_hi:[1,0,1] neg_lo:[1,0,0]
    ds_write_addtid_b32 v145 offset:18576
    s_waitcnt vmcnt(0)
    v_pk_mul_f16 v146, v116, v118 op_sel:[0,0] op_sel_hi:[0,1]
    v_pk_fma_f16 v146, v116, v118, v146 op_sel:[1,1,0] op_sel_hi:[1,0,1] neg_lo:[1,0,0]
    v_lshlrev_b32 v216, 16, v12
    v_pk_mul_f16 v147, v139, v118 op_sel:[0,0] op_sel_hi:[0,1]
    v_pk_fma_f16 v147, v139, v118, v147 op_sel:[1,1,0] op_sel_hi:[1,0,1] neg_lo:[1,0,0]
    v_lshlrev_b32 v217, 16, v13
    v_pk_mul_f16 v148, v117, v118 op_sel:[0,0] op_sel_hi:[0,1]
    v_lshlrev_b32 v218, 16, v14
    v_pk_fma_f16 v148, v117, v118, v148 op_sel:[1,1,0] op_sel_hi:[1,0,1] neg_lo:[1,0,0]
    v_lshlrev_b32 v219, 16, v15
    v_pk_mul_f16 v149, v141, v118 op_sel:[0,0] op_sel_hi:[0,1]
    v_pk_fma_f16 v149, v141, v118, v149 op_sel:[1,1,0] op_sel_hi:[1,0,1] neg_lo:[1,0,0]
    v_mul_f32 v212, v218, v216
    ds_write_addtid_b32 v146 offset:20640
    ds_write_addtid_b32 v147 offset:22704
    ds_write_addtid_b32 v148 offset:24768
    ds_write_addtid_b32 v149 offset:26832
    v_pk_mul_f16 v150, v142, v118 op_sel:[0,0] op_sel_hi:[0,1]
    v_pk_fma_f16 v150, v142, v118, v150 op_sel:[1,1,0] op_sel_hi:[1,0,1] neg_lo:[1,0,0]
    v_mul_f32 v213, v218, v217
    v_pk_mul_f16 v151, v143, v118 op_sel:[0,0] op_sel_hi:[0,1]
    v_fma_f32 v212, -v219, v217, v212
    v_pk_fma_f16 v151, v143, v118, v151 op_sel:[1,1,0] op_sel_hi:[1,0,1] neg_lo:[1,0,0]
    v_fma_f32 v213, -v219, v216, -v213
    v_mul_f32 v184, v187, v187
    v_mul_f32 v185, v186, v187 mul:2
    v_and_b32 v216, s43, v12
    v_fma_f32 v184, v186, v186, -v184
    v_cvt_pk_f16_f32 v119, v184, v185
    v_and_b32 v217, s43, v13
    v_pk_mul_f16 v228, v115, v119 op_sel:[0,0] op_sel_hi:[0,1]
    v_and_b32 v218, s43, v14
    v_pk_fma_f16 v228, v115, v119, v228 op_sel:[1,1,0] op_sel_hi:[1,0,1] neg_lo:[1,0,0]
    ds_write_addtid_b32 v150 offset:28896
    ds_write_addtid_b32 v151 offset:30960
    ds_write_addtid_b32 v119 offset:33024
    ds_write_addtid_b32 v228 offset:35088
    v_and_b32 v219, s43, v15
    v_pk_mul_f16 v229, v116, v119 op_sel:[0,0] op_sel_hi:[0,1]
    v_mul_f32 v214, v218, v216
    v_pk_fma_f16 v229, v116, v119, v229 op_sel:[1,1,0] op_sel_hi:[1,0,1] neg_lo:[1,0,0]
    v_mul_f32 v215, v218, v217
    v_pk_mul_f16 v230, v139, v119 op_sel:[0,0] op_sel_hi:[0,1]
    v_fma_f32 v214, -v219, v217, v214
    v_pk_fma_f16 v230, v139, v119, v230 op_sel:[1,1,0] op_sel_hi:[1,0,1] neg_lo:[1,0,0]
    v_fma_f32 v215, -v219, v216, -v215
    v_pk_mul_f16 v221, v117, v119 op_sel:[0,0] op_sel_hi:[0,1]
    v_pk_fma_f16 v221, v117, v119, v221 op_sel:[1,1,0] op_sel_hi:[1,0,1] neg_lo:[1,0,0]
    v_max3_f32 v220, |v212|, |v213|, |v214|
    v_max_f32 v220, v220, |v215|
    v_pk_mul_f16 v222, v141, v119 op_sel:[0,0] op_sel_hi:[0,1]
    v_pk_fma_f16 v222, v141, v119, v222 op_sel:[1,1,0] op_sel_hi:[1,0,1] neg_lo:[1,0,0]
    v_max_u32_dpp v220, v220, v220 quad_perm:[1,0,3,2] row_mask:0xf bank_mask:0xf
    ds_write_addtid_b32 v229 offset:37152
    ds_write_addtid_b32 v230 offset:39216
    ds_write_addtid_b32 v221 offset:41280
    ds_write_addtid_b32 v222 offset:43344
    v_max_u32_dpp v220, v220, v220 quad_perm:[2,3,0,1] row_mask:0xf bank_mask:0xf
    v_pk_mul_f16 v223, v142, v119 op_sel:[0,0] op_sel_hi:[0,1]
    v_pk_fma_f16 v223, v142, v119, v223 op_sel:[1,1,0] op_sel_hi:[1,0,1] neg_lo:[1,0,0]
    v_max_u32_dpp v220, v220, v220 row_half_mirror row_mask:0xf bank_mask:0xf
    v_pk_mul_f16 v224, v143, v119 op_sel:[0,0] op_sel_hi:[0,1]
    s_nop 0
    v_max_u32_dpp v220, v220, v220 row_mirror row_mask:0xf bank_mask:0xf
    v_pk_fma_f16 v224, v143, v119, v224 op_sel:[1,1,0] op_sel_hi:[1,0,1] neg_lo:[1,0,0]
    s_nop 0
    v_max_u32_dpp v220, v220, v220 row_bcast:15 row_mask:0xa bank_mask:0xf
    v_pk_mul_f16 v225, v118, v119 op_sel:[0,0] op_sel_hi:[0,1]
    s_nop 0
    v_max_u32_dpp v220, v220, v220 row_bcast:31 row_mask:0xc bank_mask:0xf
    v_pk_fma_f16 v225, v118, v119, v225 op_sel:[1,1,0] op_sel_hi:[1,0,1] neg_lo:[1,0,0]
    v_readlane_b32 s50, v220, 63
    v_pk_mul_f16 v226, v145, v119 op_sel:[0,0] op_sel_hi:[0,1]
    s_lshr_b32 s50, s50, 23
    s_sub_u32 s50, 267, s50
    s_min_u32 s50, s50, 253
    s_sub_u32 s51, 254, s50
    s_lshl_b32 s50, s50, 23
    s_lshl_b32 s51, s51, 23
    v_pk_fma_f16 v226, v145, v119, v226 op_sel:[1,1,0] op_sel_hi:[1,0,1] neg_lo:[1,0,0]
    v_mul_f32 v212, s50, v212
    ds_write_addtid_b32 v223 offset:45408
    ds_write_addtid_b32 v224 offset:47472
    ds_write_addtid_b32 v225 offset:49536
    ds_write_addtid_b32 v226 offset:51600
    v_pk_mul_f16 v227, v146, v119 op_sel:[0,0] op_sel_hi:[0,1]
    v_mul_f32 v213, s50, v213
    v_pk_fma_f16 v227, v146, v119, v227 op_sel:[1,1,0] op_sel_hi:[1,0,1] neg_lo:[1,0,0]
    v_mul_f32 v214, s50, v214
    v_pk_mul_f16 v228, v147, v119 op_sel:[0,0] op_sel_hi:[0,1]
    v_mul_f32 v215, s50, v215
    v_pk_fma_f16 v228, v147, v119, v228 op_sel:[1,1,0] op_sel_hi:[1,0,1] neg_lo:[1,0,0]
    v_mul_f32 v19, s51, v19
    v_pk_mul_f16 v229, v148, v119 op_sel:[0,0] op_sel_hi:[0,1]
    v_mul_f32 v186, v185, v185
    v_pk_fma_f16 v229, v148, v119, v229 op_sel:[1,1,0] op_sel_hi:[1,0,1] neg_lo:[1,0,0]
    v_mul_f32 v187, v184, v185 mul:2
    v_pk_mul_f16 v230, v149, v119 op_sel:[0,0] op_sel_hi:[0,1]
    v_pk_fma_f16 v230, v149, v119, v230 op_sel:[1,1,0] op_sel_hi:[1,0,1] neg_lo:[1,0,0]
    v_fma_f32 v186, v184, v184, -v186
    ds_write_addtid_b32 v227 offset:53664
    ds_write_addtid_b32 v228 offset:55728
    ds_write_addtid_b32 v229 offset:57792
    ds_write_addtid_b32 v230 offset:59856
    global_load_dwordx2 v[232:233], v248, s[4:5]
    v_cvt_pk_f16_f32 v120, v186, v187
    v_pk_mul_f16 v221, v150, v119 op_sel:[0,0] op_sel_hi:[0,1]
    v_pk_fma_f16 v221, v150, v119, v221 op_sel:[1,1,0] op_sel_hi:[1,0,1] neg_lo:[1,0,0]
    v_pk_mul_f16 v121, v120, v120 op_sel:[0,0] op_sel_hi:[0,1]
    v_pk_fma_f16 v121, v120, v120, v121 op_sel:[1,1,0] op_sel_hi:[1,0,1] neg_lo:[1,0,0]
    v_pk_mul_f16 v222, v151, v119 op_sel:[0,0] op_sel_hi:[0,1]
    v_pk_fma_f16 v222, v151, v119, v222 op_sel:[1,1,0] op_sel_hi:[1,0,1] neg_lo:[1,0,0]
    v_pk_mul_f16 v122, v121, v121 op_sel:[0,0] op_sel_hi:[0,1]
    v_pk_fma_f16 v122, v121, v121, v122 op_sel:[1,1,0] op_sel_hi:[1,0,1] neg_lo:[1,0,0]
    v_cvt_pk_f16_f32 v156, v212, v213
    ds_write_addtid_b32 v221 offset:61920
    ds_write_addtid_b32 v222 offset:63984
    s_mov_b32 m0, s52
    v_pk_mul_f16 v157, v156, v112 op_sel:[0,0] op_sel_hi:[0,1] neg_hi:[1,0]
    v_pk_fma_f16 v157, v156, v112, v157 op_sel:[1,1,0] op_sel_hi:[1,0,1]
    ds_read_b128 v[48:51], v9 offset:0
    ds_write_addtid_b32 v156 offset:0
    ds_read_b128 v[52:55], v9 offset:32
    ds_read_b128 v[56:59], v9 offset:64
    v_pk_mul_f16 v158, v156, v113 op_sel:[0,0] op_sel_hi:[0,1] neg_hi:[1,0]
    v_pk_fma_f16 v158, v156, v113, v158 op_sel:[1,1,0] op_sel_hi:[1,0,1]
    ds_write_addtid_b32 v157 offset:2064
    ds_read_b128 v[60:63], v9 offset:96
    ds_read_b128 v[64:67], v9 offset:128
    ds_write_addtid_b32 v158 offset:4128
    v_pk_mul_f16 v159, v157, v113 op_sel:[0,0] op_sel_hi:[0,1] neg_hi:[1,0]
    v_pk_fma_f16 v159, v157, v113, v159 op_sel:[1,1,0] op_sel_hi:[1,0,1]
    v_pk_mul_f16 v160, v156, v114 op_sel:[0,0] op_sel_hi:[0,1] neg_hi:[1,0]
    ds_read_b128 v[68:71], v9 offset:160
    ds_write_addtid_b32 v159 offset:6192
    ds_read_b128 v[72:75], v9 offset:192
    ds_read_b128 v[76:79], v9 offset:224
    global_load_dwordx2 v[234:235], v248, s[4:5] offset:896
    v_pk_fma_f16 v160, v156, v114, v160 op_sel:[1,1,0] op_sel_hi:[1,0,1]
    v_and_b32 v199, s43, v11
    v_pk_mul_f16 v161, v157, v114 op_sel:[0,0] op_sel_hi:[0,1] neg_hi:[1,0]
    v_and_b32 v196, s43, v10
    v_pk_fma_f16 v161, v157, v114, v161 op_sel:[1,1,0] op_sel_hi:[1,0,1]
    v_mul_f32 v197, v199, v17
    v_pk_mul_f16 v162, v158, v114 op_sel:[0,0] op_sel_hi:[0,1] neg_hi:[1,0]
    v_mul_f32 v196, v196, v16
    v_pk_fma_f16 v162, v158, v114, v162 op_sel:[1,1,0] op_sel_hi:[1,0,1]
    v_fma_f32 v198, v199, v17, -v197
    v_pk_mul_f16 v163, v159, v114 op_sel:[0,0] op_sel_hi:[0,1] neg_hi:[1,0]
    v_pk_fma_f16 v163, v159, v114, v163 op_sel:[1,1,0] op_sel_hi:[1,0,1]
    v_fract_f32 v201, v197
    ds_write_addtid_b32 v160 offset:8256
    ds_write_addtid_b32 v161 offset:10320
    ds_write_addtid_b32 v162 offset:12384
    ds_write_addtid_b32 v163 offset:14448
    v_fma_f32 v198, v199, v18, v198
    v_pk_mul_f16 v164, v156, v115 op_sel:[0,0] op_sel_hi:[0,1] neg_hi:[1,0]
    v_pk_fma_f16 v164, v156, v115, v164 op_sel:[1,1,0] op_sel_hi:[1,0,1]
    v_exp_f32 v199, v196
    v_add_f32 v201, v201, v198
    v_pk_mul_f16 v165, v156, v120 op_sel:[0,0] op_sel_hi:[0,1] neg_hi:[1,0]
    v_pk_fma_f16 v165, v156, v120, v165 op_sel:[1,1,0] op_sel_hi:[1,0,1]
    v_cos_f32 v200, v201
    v_sin_f32 v201, v201
    v_pk_mul_f16 v166, v158, v120 op_sel:[0,0] op_sel_hi:[0,1] neg_hi:[1,0]
    v_pk_fma_f16 v166, v158, v120, v166 op_sel:[1,1,0] op_sel_hi:[1,0,1]
    v_mul_f32 v200, v200, v199
    v_pk_mul_f16 v167, v160, v120 op_sel:[0,0] op_sel_hi:[0,1] neg_hi:[1,0]
    v_mul_f32 v201, v201, v199
    v_pk_fma_f16 v167, v160, v120, v167 op_sel:[1,1,0] op_sel_hi:[1,0,1]
    v_cvt_pk_f16_f32 v127, v200, v201
    ds_write_addtid_b32 v164 offset:24768
    ds_write_addtid_b32 v165 offset:18576
    ds_write_addtid_b32 v166 offset:20640
    ds_write_addtid_b32 v167 offset:22704
    global_load_dwordx2 v[236:237], v249, s[4:5]
    v_pk_mul_f16 v168, v162, v120 op_sel:[0,0] op_sel_hi:[0,1] neg_hi:[1,0]
    v_mul_f32 v202, v201, v201
    v_pk_fma_f16 v168, v162, v120, v168 op_sel:[1,1,0] op_sel_hi:[1,0,1]
    v_mul_f32 v203, v200, v201 mul:2
    v_pk_mul_f16 v169, v164, v120 op_sel:[0,0] op_sel_hi:[0,1] neg_hi:[1,0]
    v_fma_f32 v202, v200, v200, -v202
    v_pk_fma_f16 v169, v164, v120, v169 op_sel:[1,1,0] op_sel_hi:[1,0,1]
    v_cvt_pk_f16_f32 v128, v202, v203
    v_pk_mul_f16 v170, v160, v121 op_sel:[0,0] op_sel_hi:[0,1] neg_hi:[1,0]
    v_mul_f32 v200, v203, v203
    v_pk_fma_f16 v170, v160, v121, v170 op_sel:[1,1,0] op_sel_hi:[1,0,1]
    v_mul_f32 v201, v202, v203 mul:2
    v_pk_mul_f16 v171, v164, v121 op_sel:[0,0] op_sel_hi:[0,1] neg_hi:[1,0]
    v_fma_f32 v200, v202, v202, -v200
    v_pk_fma_f16 v171, v164, v121, v171 op_sel:[1,1,0] op_sel_hi:[1,0,1]
    ds_write_addtid_b32 v168 offset:28896
    ds_write_addtid_b32 v169 offset:30960
    ds_write_addtid_b32 v170 offset:33024
    ds_write_addtid_b32 v171 offset:35088
    v_cvt_pk_f16_f32 v129, v200, v201
    v_pk_mul_f16 v172, v167, v121 op_sel:[0,0] op_sel_hi:[0,1] neg_hi:[1,0]
    v_mul_f32 v202, v201, v201
    v_pk_fma_f16 v172, v167, v121, v172 op_sel:[1,1,0] op_sel_hi:[1,0,1]
    v_mul_f32 v203, v200, v201 mul:2
    v_pk_mul_f16 v173, v169, v121 op_sel:[0,0] op_sel_hi:[0,1] neg_hi:[1,0]
    v_fma_f32 v202, v200, v200, -v202
    v_pk_fma_f16 v173, v169, v121, v173 op_sel:[1,1,0] op_sel_hi:[1,0,1]
    v_cvt_pk_f16_f32 v130, v202, v203
    v_pk_mul_f16 v174, v164, v122 op_sel:[0,0] op_sel_hi:[0,1] neg_hi:[1,0]
    v_pk_fma_f16 v174, v164, v122, v174 op_sel:[1,1,0] op_sel_hi:[1,0,1]
    v_mul_f32 v200, v203, v203
    v_mul_f32 v201, v202, v203 mul:2
    v_pk_mul_f16 v175, v169, v122 op_sel:[0,0] op_sel_hi:[0,1] neg_hi:[1,0]
    v_pk_fma_f16 v175, v169, v122, v175 op_sel:[1,1,0] op_sel_hi:[1,0,1]
    v_fma_f32 v200, v202, v202, -v200
    ds_write_addtid_b32 v172 offset:41280
    ds_write_addtid_b32 v173 offset:43344
    ds_write_addtid_b32 v174 offset:37152
    ds_write_addtid_b32 v175 offset:39216
    global_load_dwordx2 v[238:239], v249, s[4:5] offset:896
    v_cvt_pk_f16_f32 v131, v200, v201
    v_pk_mul_f16 v176, v171, v122 op_sel:[0,0] op_sel_hi:[0,1] neg_hi:[1,0]
    v_pk_fma_f16 v176, v171, v122, v176 op_sel:[1,1,0] op_sel_hi:[1,0,1]
    v_mul_f32 v202, v201, v201
    v_mul_f32 v203, v200, v201 mul:2
    v_pk_mul_f16 v177, v173, v122 op_sel:[0,0] op_sel_hi:[0,1] neg_hi:[1,0]
    v_pk_fma_f16 v177, v173, v122, v177 op_sel:[1,1,0] op_sel_hi:[1,0,1]
    v_fma_f32 v202, v200, v200, -v202
    v_cvt_pk_f16_f32 v132, v202, v203
    ds_write_addtid_b32 v176 offset:45408
    ds_write_addtid_b32 v177 offset:47472
    ds_read_b128 v[80:83], v8 offset:0
    ds_read_b128 v[84:87], v8 offset:32
    ds_read_b128 v[88:91], v8 offset:64
    ds_read_b128 v[92:95], v8 offset:96
    ds_read_b128 v[96:99], v8 offset:128
    ds_read_b128 v[100:103], v8 offset:160
    ds_read_b128 v[104:107], v8 offset:192
    ds_read_b128 v[108:111], v8 offset:224
    s_mov_b32 m0, s53
    v_pk_mul_f16 v133, v132, v132 op_sel:[0,0] op_sel_hi:[0,1]
    v_pk_mul_f16 v139, v127, v128 op_sel:[0,0] op_sel_hi:[0,1]
    v_pk_fma_f16 v139, v127, v128, v139 op_sel:[1,1,0] op_sel_hi:[1,0,1] neg_lo:[1,0,0]
    v_pk_fma_f16 v133, v132, v132, v133 op_sel:[1,1,0] op_sel_hi:[1,0,1] neg_lo:[1,0,0]
    ds_write_addtid_b32 v127 offset:2064
    ds_write_addtid_b32 v128 offset:4128
    ds_write_addtid_b32 v139 offset:6192
    ds_write_addtid_b32 v129 offset:8256
    v_pk_mul_f16 v141, v127, v129 op_sel:[0,0] op_sel_hi:[0,1]
    v_pk_fma_f16 v141, v127, v129, v141 op_sel:[1,1,0] op_sel_hi:[1,0,1] neg_lo:[1,0,0]
    v_pk_mul_f16 v134, v133, v133 op_sel:[0,0] op_sel_hi:[0,1]
    v_pk_mul_f16 v142, v128, v129 op_sel:[0,0] op_sel_hi:[0,1]
    v_pk_fma_f16 v142, v128, v129, v142 op_sel:[1,1,0] op_sel_hi:[1,0,1] neg_lo:[1,0,0]
    v_pk_fma_f16 v134, v133, v133, v134 op_sel:[1,1,0] op_sel_hi:[1,0,1] neg_lo:[1,0,0]
    v_pk_mul_f16 v143, v139, v129 op_sel:[0,0] op_sel_hi:[0,1]
    v_pk_fma_f16 v143, v139, v129, v143 op_sel:[1,1,0] op_sel_hi:[1,0,1] neg_lo:[1,0,0]
    v_mul_f32 v197, 0x3e000000, v197
    ds_write_addtid_b32 v141 offset:10320
    ds_write_addtid_b32 v142 offset:12384
    ds_write_addtid_b32 v143 offset:14448
    ds_write_addtid_b32 v130 offset:16512
    v_pk_mul_f16 v145, v127, v130 op_sel:[0,0] op_sel_hi:[0,1]
    v_mul_f32 v196, 0x3e000000, v196
    v_pk_fma_f16 v145, v127, v130, v145 op_sel:[1,1,0] op_sel_hi:[1,0,1] neg_lo:[1,0,0]
    v_pk_mul_f16 v146, v128, v130 op_sel:[0,0] op_sel_hi:[0,1]
    v_fract_f32 v205, v197
    v_pk_fma_f16 v146, v128, v130, v146 op_sel:[1,1,0] op_sel_hi:[1,0,1] neg_lo:[1,0,0]
    v_pk_mul_f16 v147, v139, v130 op_sel:[0,0] op_sel_hi:[0,1]
    v_exp_f32 v198, v196
    v_pk_fma_f16 v147, v139, v130, v147 op_sel:[1,1,0] op_sel_hi:[1,0,1] neg_lo:[1,0,0]
    v_pk_mul_f16 v148, v129, v130 op_sel:[0,0] op_sel_hi:[0,1]
    v_cos_f32 v204, v205
    v_pk_fma_f16 v148, v129, v130, v148 op_sel:[1,1,0] op_sel_hi:[1,0,1] neg_lo:[1,0,0]
    ds_write_addtid_b32 v145 offset:18576
    ds_write_addtid_b32 v146 offset:20640
    ds_write_addtid_b32 v147 offset:22704
    ds_write_addtid_b32 v148 offset:24768
    v_pk_mul_f16 v149, v141, v130 op_sel:[0,0] op_sel_hi:[0,1]
    v_sin_f32 v205, v205
    s_waitcnt lgkmcnt(12)
    v_pk_fma_f16 v149, v141, v130, v149 op_sel:[1,1,0] op_sel_hi:[1,0,1] neg_lo:[1,0,0]
    v_pk_mul_f16 v150, v142, v130 op_sel:[0,0] op_sel_hi:[0,1]
    v_pk_fma_f16 v150, v142, v130, v150 op_sel:[1,1,0] op_sel_hi:[1,0,1] neg_lo:[1,0,0]
    v_pk_mul_f16 v151, v143, v130 op_sel:[0,0] op_sel_hi:[0,1]
    v_pk_fma_f16 v151, v143, v130, v151 op_sel:[1,1,0] op_sel_hi:[1,0,1] neg_lo:[1,0,0]
    ds_write_addtid_b32 v149 offset:26832
    ds_write_addtid_b32 v150 offset:28896
    ds_write_addtid_b32 v151 offset:30960
    v_mfma_f32_32x32x16_f16 v[32:47], v[80:83], v[48:51], 0
    v_mul_f32 v204, v204, v198
    v_pk_mul_f16 v228, v127, v131 op_sel:[0,0] op_sel_hi:[0,1]
    v_pk_fma_f16 v228, v127, v131, v228 op_sel:[1,1,0] op_sel_hi:[1,0,1] neg_lo:[1,0,0]
    v_pk_mul_f16 v229, v128, v131 op_sel:[0,0] op_sel_hi:[0,1]
    v_pk_fma_f16 v229, v128, v131, v229 op_sel:[1,1,0] op_sel_hi:[1,0,1] neg_lo:[1,0,0]
    ds_write_addtid_b32 v131 offset:33024
    ds_write_addtid_b32 v228 offset:35088
    v_mfma_f32_32x32x16_f16 v[32:47], v[84:87], v[52:55], v[32:47]
    v_pk_mul_f16 v230, v139, v131 op_sel:[0,0] op_sel_hi:[0,1]
    v_mul_f32 v205, v205, v198
    v_pk_fma_f16 v230, v139, v131, v230 op_sel:[1,1,0] op_sel_hi:[1,0,1] neg_lo:[1,0,0]
    v_pk_mul_f16 v221, v129, v131 op_sel:[0,0] op_sel_hi:[0,1]
    v_pk_fma_f16 v221, v129, v131, v221 op_sel:[1,1,0] op_sel_hi:[1,0,1] neg_lo:[1,0,0]
    ds_write_addtid_b32 v229 offset:37152
    ds_write_addtid_b32 v230 offset:39216
    v_mfma_f32_32x32x16_f16 v[32:47], v[88:91], v[56:59], v[32:47]
    v_pk_mul_f16 v222, v141, v131 op_sel:[0,0] op_sel_hi:[0,1]
    v_pk_fma_f16 v222, v141, v131, v222 op_sel:[1,1,0] op_sel_hi:[1,0,1] neg_lo:[1,0,0]
    v_cvt_pk_f16_f32 v124, v204, v205
    v_pk_mul_f16 v223, v142, v131 op_sel:[0,0] op_sel_hi:[0,1]
    v_pk_fma_f16 v223, v142, v131, v223 op_sel:[1,1,0] op_sel_hi:[1,0,1] neg_lo:[1,0,0]
    ds_write_addtid_b32 v221 offset:41280
    ds_write_addtid_b32 v222 offset:43344
    v_mfma_f32_32x32x16_f16 v[32:47], v[92:95], v[60:63], v[32:47]
    v_pk_mul_f16 v224, v143, v131 op_sel:[0,0] op_sel_hi:[0,1]
    v_pk_fma_f16 v224, v143, v131, v224 op_sel:[1,1,0] op_sel_hi:[1,0,1] neg_lo:[1,0,0]
    v_pk_mul_f16 v225, v130, v131 op_sel:[0,0] op_sel_hi:[0,1]
    v_pk_mul_f16 v125, v124, v124 op_sel:[0,0] op_sel_hi:[0,1]
    v_pk_fma_f16 v225, v130, v131, v225 op_sel:[1,1,0] op_sel_hi:[1,0,1] neg_lo:[1,0,0]
    ds_write_addtid_b32 v223 offset:45408
    ds_write_addtid_b32 v224 offset:47472
    v_mfma_f32_32x32x16_f16 v[32:47], v[96:99], v[64:67], v[32:47]
    v_pk_mul_f16 v226, v145, v131 op_sel:[0,0] op_sel_hi:[0,1]
    v_pk_fma_f16 v226, v145, v131, v226 op_sel:[1,1,0] op_sel_hi:[1,0,1] neg_lo:[1,0,0]
    v_pk_mul_f16 v227, v146, v131 op_sel:[0,0] op_sel_hi:[0,1]
    v_pk_fma_f16 v227, v146, v131, v227 op_sel:[1,1,0] op_sel_hi:[1,0,1] neg_lo:[1,0,0]
    v_pk_fma_f16 v125, v124, v124, v125 op_sel:[1,1,0] op_sel_hi:[1,0,1] neg_lo:[1,0,0]
    ds_write_addtid_b32 v225 offset:49536
    ds_write_addtid_b32 v226 offset:51600
    ds_write_addtid_b32 v227 offset:53664
    v_mfma_f32_32x32x16_f16 v[32:47], v[100:103], v[68:71], v[32:47]
    v_pk_mul_f16 v228, v147, v131 op_sel:[0,0] op_sel_hi:[0,1]
    v_pk_fma_f16 v228, v147, v131, v228 op_sel:[1,1,0] op_sel_hi:[1,0,1] neg_lo:[1,0,0]
    v_pk_mul_f16 v229, v148, v131 op_sel:[0,0] op_sel_hi:[0,1]
    v_pk_fma_f16 v229, v148, v131, v229 op_sel:[1,1,0] op_sel_hi:[1,0,1] neg_lo:[1,0,0]
    v_pk_mul_f16 v230, v149, v131 op_sel:[0,0] op_sel_hi:[0,1]
    ds_write_addtid_b32 v228 offset:55728
    ds_write_addtid_b32 v229 offset:57792
    v_mfma_f32_32x32x16_f16 v[32:47], v[104:107], v[72:75], v[32:47]
    v_pk_fma_f16 v230, v149, v131, v230 op_sel:[1,1,0] op_sel_hi:[1,0,1] neg_lo:[1,0,0]
    v_pk_mul_f16 v126, v125, v125 op_sel:[0,0] op_sel_hi:[0,1]
    v_pk_mul_f16 v221, v150, v131 op_sel:[0,0] op_sel_hi:[0,1]
    v_pk_fma_f16 v221, v150, v131, v221 op_sel:[1,1,0] op_sel_hi:[1,0,1] neg_lo:[1,0,0]
    v_pk_mul_f16 v222, v151, v131 op_sel:[0,0] op_sel_hi:[0,1]
    ds_write_addtid_b32 v230 offset:59856
    ds_write_addtid_b32 v221 offset:61920
    v_mfma_f32_32x32x16_f16 v[32:47], v[108:111], v[76:79], v[32:47]
    v_pk_fma_f16 v222, v151, v131, v222 op_sel:[1,1,0] op_sel_hi:[1,0,1] neg_lo:[1,0,0]
    v_pk_fma_f16 v126, v125, v125, v126 op_sel:[1,1,0] op_sel_hi:[1,0,1] neg_lo:[1,0,0]
    v_cvt_pk_f16_f32 v156, v214, v215
    ds_write_addtid_b32 v222 offset:63984
    s_mov_b32 m0, s52
    v_pk_mul_f16 v157, v156, v124 op_sel:[0,0] op_sel_hi:[0,1] neg_hi:[1,0]
    v_pk_fma_f16 v157, v156, v124, v157 op_sel:[1,1,0] op_sel_hi:[1,0,1]
    v_pk_mul_f16 v158, v156, v125 op_sel:[0,0] op_sel_hi:[0,1] neg_hi:[1,0]
    v_pk_fma_f16 v158, v156, v125, v158 op_sel:[1,1,0] op_sel_hi:[1,0,1]
    ds_write_addtid_b32 v156 offset:0
    ds_read_b128 v[48:51], v9 offset:0
    ds_write_addtid_b32 v157 offset:2064
    ds_read_b128 v[52:55], v9 offset:32
    v_pk_mul_f16 v159, v157, v125 op_sel:[0,0] op_sel_hi:[0,1] neg_hi:[1,0]
    v_pk_fma_f16 v159, v157, v125, v159 op_sel:[1,1,0] op_sel_hi:[1,0,1]
    v_pk_mul_f16 v160, v156, v126 op_sel:[0,0] op_sel_hi:[0,1] neg_hi:[1,0]
    v_pk_fma_f16 v160, v156, v126, v160 op_sel:[1,1,0] op_sel_hi:[1,0,1]
    ds_write_addtid_b32 v158 offset:4128
    ds_write_addtid_b32 v159 offset:6192
    ds_read_b128 v[56:59], v9 offset:64
    ds_write_addtid_b32 v160 offset:8256
    v_pk_mul_f16 v161, v157, v126 op_sel:[0,0] op_sel_hi:[0,1] neg_hi:[1,0]
    v_pk_fma_f16 v161, v157, v126, v161 op_sel:[1,1,0] op_sel_hi:[1,0,1]
    v_pk_mul_f16 v162, v158, v126 op_sel:[0,0] op_sel_hi:[0,1] neg_hi:[1,0]
    v_pk_fma_f16 v162, v158, v126, v162 op_sel:[1,1,0] op_sel_hi:[1,0,1]
    ds_read_b128 v[60:63], v9 offset:96
    ds_write_addtid_b32 v161 offset:10320
    ds_read_b128 v[64:67], v9 offset:128
    ds_write_addtid_b32 v162 offset:12384
    v_pk_mul_f16 v163, v159, v126 op_sel:[0,0] op_sel_hi:[0,1] neg_hi:[1,0]
    v_pk_fma_f16 v163, v159, v126, v163 op_sel:[1,1,0] op_sel_hi:[1,0,1]
    v_pk_mul_f16 v164, v156, v127 op_sel:[0,0] op_sel_hi:[0,1] neg_hi:[1,0]
    v_pk_fma_f16 v164, v156, v127, v164 op_sel:[1,1,0] op_sel_hi:[1,0,1]
    v_pk_mul_f16 v165, v156, v132 op_sel:[0,0] op_sel_hi:[0,1] neg_hi:[1,0]
    ds_write_addtid_b32 v163 offset:14448
    ds_read_b128 v[68:71], v9 offset:160
    ds_write_addtid_b32 v164 offset:24768
    ds_read_b128 v[72:75], v9 offset:192
    v_pk_fma_f16 v165, v156, v132, v165 op_sel:[1,1,0] op_sel_hi:[1,0,1]
    v_pk_mul_f16 v166, v158, v132 op_sel:[0,0] op_sel_hi:[0,1] neg_hi:[1,0]
    v_pk_fma_f16 v166, v158, v132, v166 op_sel:[1,1,0] op_sel_hi:[1,0,1]
    v_pk_mul_f16 v167, v160, v132 op_sel:[0,0] op_sel_hi:[0,1] neg_hi:[1,0]
    v_pk_fma_f16 v167, v160, v132, v167 op_sel:[1,1,0] op_sel_hi:[1,0,1]
    ds_write_addtid_b32 v165 offset:18576
    ds_read_b128 v[76:79], v9 offset:224
    ds_write_addtid_b32 v166 offset:20640
    ds_write_addtid_b32 v167 offset:22704
    v_pk_mul_f16 v168, v162, v132 op_sel:[0,0] op_sel_hi:[0,1] neg_hi:[1,0]
    v_pk_fma_f16 v168, v162, v132, v168 op_sel:[1,1,0] op_sel_hi:[1,0,1]
    v_pk_mul_f16 v169, v164, v132 op_sel:[0,0] op_sel_hi:[0,1] neg_hi:[1,0]
    v_pk_fma_f16 v169, v164, v132, v169 op_sel:[1,1,0] op_sel_hi:[1,0,1]
    v_pk_mul_f16 v170, v160, v133 op_sel:[0,0] op_sel_hi:[0,1] neg_hi:[1,0]
    v_pk_fma_f16 v170, v160, v133, v170 op_sel:[1,1,0] op_sel_hi:[1,0,1]
    v_pk_mul_f16 v171, v164, v133 op_sel:[0,0] op_sel_hi:[0,1] neg_hi:[1,0]
    v_pk_fma_f16 v171, v164, v133, v171 op_sel:[1,1,0] op_sel_hi:[1,0,1]
    ds_write_addtid_b32 v168 offset:28896
    ds_write_addtid_b32 v169 offset:30960
    ds_write_addtid_b32 v170 offset:33024
    ds_write_addtid_b32 v171 offset:35088
    v_pk_mul_f16 v172, v167, v133 op_sel:[0,0] op_sel_hi:[0,1] neg_hi:[1,0]
    v_pk_fma_f16 v172, v167, v133, v172 op_sel:[1,1,0] op_sel_hi:[1,0,1]
    v_pk_mul_f16 v173, v169, v133 op_sel:[0,0] op_sel_hi:[0,1] neg_hi:[1,0]
    v_pk_fma_f16 v173, v169, v133, v173 op_sel:[1,1,0] op_sel_hi:[1,0,1]
    v_pk_mul_f16 v174, v164, v134 op_sel:[0,0] op_sel_hi:[0,1] neg_hi:[1,0]
    v_pk_fma_f16 v174, v164, v134, v174 op_sel:[1,1,0] op_sel_hi:[1,0,1]
    v_pk_mul_f16 v175, v169, v134 op_sel:[0,0] op_sel_hi:[0,1] neg_hi:[1,0]
    v_pk_fma_f16 v175, v169, v134, v175 op_sel:[1,1,0] op_sel_hi:[1,0,1]
    ds_write_addtid_b32 v172 offset:41280
    ds_write_addtid_b32 v173 offset:43344
    ds_write_addtid_b32 v174 offset:37152
    ds_write_addtid_b32 v175 offset:39216
    v_pk_mul_f16 v176, v171, v134 op_sel:[0,0] op_sel_hi:[0,1] neg_hi:[1,0]
    v_pk_fma_f16 v176, v171, v134, v176 op_sel:[1,1,0] op_sel_hi:[1,0,1]
    v_pk_mul_f16 v177, v173, v134 op_sel:[0,0] op_sel_hi:[0,1] neg_hi:[1,0]
    v_pk_fma_f16 v177, v173, v134, v177 op_sel:[1,1,0] op_sel_hi:[1,0,1]
    ds_write_addtid_b32 v176 offset:45408
    ds_write_addtid_b32 v177 offset:47472
    ds_read_b128 v[80:83], v8 offset:0
    ds_read_b128 v[84:87], v8 offset:32
    ds_read_b128 v[88:91], v8 offset:64
    ds_read_b128 v[92:95], v8 offset:96
    ds_read_b128 v[96:99], v8 offset:128
    ds_read_b128 v[100:103], v8 offset:160
    ds_read_b128 v[104:107], v8 offset:192
    ds_read_b128 v[108:111], v8 offset:224
    global_load_dwordx2 v[30:31], v26, s[34:35] sc1
    global_load_dwordx4 v[200:203], v252, s[36:37] offset:-4096 sc1
    global_load_dwordx4 v[204:207], v252, s[36:37] offset:0 sc1
    global_load_dwordx4 v[208:211], v253, s[36:37] offset:-4096 sc1
    global_load_dwordx4 v[212:215], v253, s[36:37] offset:0 sc1
    s_waitcnt lgkmcnt(7)
    v_mfma_f32_32x32x16_f16 v[32:47], v[80:83], v[48:51], v[32:47]
    s_waitcnt lgkmcnt(6)
    v_mfma_f32_32x32x16_f16 v[32:47], v[84:87], v[52:55], v[32:47]
    s_waitcnt lgkmcnt(5)
    v_mfma_f32_32x32x16_f16 v[32:47], v[88:91], v[56:59], v[32:47]
    s_waitcnt lgkmcnt(4)
    v_mfma_f32_32x32x16_f16 v[32:47], v[92:95], v[60:63], v[32:47]
    s_waitcnt lgkmcnt(3)
    v_mfma_f32_32x32x16_f16 v[32:47], v[96:99], v[64:67], v[32:47]
    s_waitcnt lgkmcnt(2)
    v_mfma_f32_32x32x16_f16 v[32:47], v[100:103], v[68:71], v[32:47]
    s_waitcnt lgkmcnt(1)
    v_mfma_f32_32x32x16_f16 v[32:47], v[104:107], v[72:75], v[32:47]
    s_waitcnt lgkmcnt(0)
    v_mfma_f32_32x32x16_f16 v[32:47], v[108:111], v[76:79], v[32:47]
    s_mov_b32 s60, 0xbfb8aa3b
    v_mov_b32 v22, 1
    v_mov_b32 v23, 2
    v_mov_b32 v21, 3
    v_add_u32 v216, 896, v248
    v_add_u32 v217, 896, v249
    v_add_u32 v218, 896, v250
    v_add_u32 v219, 896, v251
    s_mov_b32 s54, 0
    s_nop 2
    v_mul_f32 v32, v32, v19
    v_mul_f32 v33, v33, v19
    v_mul_f32 v34, v34, v19
    v_mul_f32 v35, v35, v19
    v_mul_f32 v36, v36, v19
    v_mul_f32 v37, v37, v19
    v_mul_f32 v38, v38, v19
    v_mul_f32 v39, v39, v19
    v_mul_f32 v40, v40, v19
    v_mul_f32 v41, v41, v19
    v_mul_f32 v42, v42, v19
    v_mul_f32 v43, v43, v19
    ds_write_b128 v20, v[32:35] offset:0
    ds_write_b128 v20, v[36:39] offset:8256
    ds_write_b128 v20, v[40:43] offset:16512
    ds_write_b32 v24, v22 offset:32
    s_setprio 3
    s_waitcnt vmcnt(0)
    s_branch L_h_chk
L_h_poll:
    global_load_dwordx2 v[30:31], v26, s[34:35] sc1
    global_load_dwordx4 v[200:203], v252, s[36:37] offset:-4096 sc1
    global_load_dwordx4 v[204:207], v252, s[36:37] offset:0 sc1
    global_load_dwordx4 v[208:211], v253, s[36:37] offset:-4096 sc1
    global_load_dwordx4 v[212:215], v253, s[36:37] offset:0 sc1
    s_waitcnt vmcnt(0)
L_h_chk:
    s_add_u32 s54, s54, 1
    v_xor_b32 v168, v31, v200
    v_bitop3_b32 v169, v201, v202, v203 bitop3:0x96
    v_xor_b32 v170, v31, v204
    v_bitop3_b32 v171, v205, v206, v207 bitop3:0x96
    v_xor_b32 v172, v31, v208
    v_bitop3_b32 v173, v209, v210, v211 bitop3:0x96
    v_xor_b32 v174, v31, v212
    v_bitop3_b32 v175, v213, v214, v215 bitop3:0x96
    v_xor_b32 v168, v168, v169
    v_xor_b32 v172, v172, v173
    v_bitop3_b32 v168, v168, v170, v171 bitop3:0xf6
    v_bitop3_b32 v172, v172, v174, v175 bitop3:0xf6
    v_bitop3_b32 v172, v172, v30, v31 bitop3:0xf9
    v_or_b32 v168, v168, v172
    v_cmp_ne_u32 vcc, 0, v168
    s_cbranch_vccz L_h_got
    s_cmp_lt_u32 s54, 131072
    s_cbranch_scc1 L_h_poll
L_h_got:
    global_load_dwordx2 v[240:241], v250, s[4:5]
    global_load_dwordx2 v[242:243], v250, s[4:5] offset:896
    global_load_dwordx2 v[244:245], v251, s[4:5]
    global_load_dwordx2 v[246:247], v251, s[4:5] offset:896
    v_lshlrev_b32 v112, 16, v232
    v_and_b32 v113, s43, v232
    v_lshlrev_b32 v114, 16, v233
    v_and_b32 v115, s43, v233
    v_lshlrev_b32 v116, 16, v234
    v_and_b32 v117, s43, v234
    v_lshlrev_b32 v118, 16, v235
    v_and_b32 v119, s43, v235
    v_and_b32 v170, s43, v200
    v_and_b32 v171, s43, v201
    v_rcp_f32 v170, v170
    v_rcp_f32 v171, v171
    v_lshlrev_b32 v168, 16, v200
    v_lshlrev_b32 v169, 16, v201
    v_mul_f32 v170, s60, v170
    v_mul_f32 v171, s60, v171
    v_mul_f32 v168, v168, v170
    v_mul_f32 v169, v169, v171
    v_fma_f32 v48, v112, v170, -v168
    v_fma_f32 v49, v113, v170, -v168
    v_fma_f32 v50, v114, v170, -v168
    v_fma_f32 v51, v115, v170, -v168
    v_fma_f32 v52, v116, v171, -v169
    v_fma_f32 v53, v117, v171, -v169
    v_fma_f32 v54, v118, v171, -v169
    v_fma_f32 v55, v119, v171, -v169
    v_cvt_pk_bf16_f32 v172, v48, v52
    v_cvt_pk_bf16_f32 v173, v49, v53
    v_cvt_pk_bf16_f32 v174, v50, v54
    v_cvt_pk_bf16_f32 v175, v51, v55
    ds_write_b32 v29, v172 offset:0
    ds_write_b32 v29, v173 offset:4608
    ds_write_b32 v29, v174 offset:9216
    ds_write_b32 v29, v175 offset:13824
    v_lshlrev_b32 v120, 16, v236
    v_and_b32 v121, s43, v236
    v_lshlrev_b32 v122, 16, v237
    v_and_b32 v123, s43, v237
    v_lshlrev_b32 v124, 16, v238
    v_and_b32 v125, s43, v238
    v_lshlrev_b32 v126, 16, v239
    v_and_b32 v127, s43, v239
    v_and_b32 v170, s43, v204
    v_and_b32 v171, s43, v205
    v_rcp_f32 v170, v170
    v_rcp_f32 v171, v171
    v_lshlrev_b32 v168, 16, v204
    v_lshlrev_b32 v169, 16, v205
    v_mul_f32 v170, s60, v170
    v_mul_f32 v171, s60, v171
    v_mul_f32 v168, v168, v170
    v_mul_f32 v169, v169, v171
    v_fma_f32 v56, v120, v170, -v168
    v_fma_f32 v57, v121, v170, -v168
    v_fma_f32 v58, v122, v170, -v168
    v_fma_f32 v59, v123, v170, -v168
    v_fma_f32 v60, v124, v171, -v169
    v_fma_f32 v61, v125, v171, -v169
    v_fma_f32 v62, v126, v171, -v169
    v_fma_f32 v63, v127, v171, -v169
    v_cvt_pk_bf16_f32 v172, v56, v60
    v_cvt_pk_bf16_f32 v173, v57, v61
    v_cvt_pk_bf16_f32 v174, v58, v62
    v_cvt_pk_bf16_f32 v175, v59, v63
    ds_write_b32 v29, v172 offset:1024
    ds_write_b32 v29, v173 offset:5632
    ds_write_b32 v29, v174 offset:10240
    ds_write_b32 v29, v175 offset:14848
    ds_write_b32 v24, v22 offset:16
    s_setprio 0
    v_max3_u32 v176, v202, v206, v210
    v_max3_u32 v176, v176, v214, 1
    s_nop 1
    v_max_u32_dpp v176, v176, v176 row_mirror row_mask:0xf bank_mask:0xf
    s_nop 1
    v_max_u32_dpp v176, v176, v176 row_bcast:15 row_mask:0xa bank_mask:0xf
    s_nop 1
    v_max_u32_dpp v176, v176, v176 row_bcast:31 row_mask:0xc bank_mask:0xf
    s_mov_b32 exec_lo, 0
    s_mov_b32 exec_hi, 0x80000000
    ds_write_b32 v24, v176
    s_mov_b64 exec, -1
    v_exp_f32 v80, v48
    v_exp_f32 v81, v49
    v_exp_f32 v82, v50
    v_exp_f32 v83, v51
    v_exp_f32 v84, v52
    v_exp_f32 v85, v53
    v_exp_f32 v86, v54
    v_exp_f32 v87, v55
    v_add_f32 v80, 1.0, v80
    v_add_f32 v81, 1.0, v81
    v_add_f32 v82, 1.0, v82
    v_add_f32 v83, 1.0, v83
    v_add_f32 v84, 1.0, v84
    v_add_f32 v85, 1.0, v85
    v_add_f32 v86, 1.0, v86
    v_add_f32 v87, 1.0, v87
    v_rcp_f32 v80, v80
    v_rcp_f32 v81, v81
    v_rcp_f32 v82, v82
    v_rcp_f32 v83, v83
    v_rcp_f32 v84, v84
    v_rcp_f32 v85, v85
    v_rcp_f32 v86, v86
    v_rcp_f32 v87, v87
    v_mul_f32 v80, v80, v48
    v_mul_f32 v81, v81, v49
    v_mul_f32 v82, v82, v50
    v_mul_f32 v83, v83, v51
    v_mul_f32 v84, v84, v52
    v_mul_f32 v85, v85, v53
    v_mul_f32 v86, v86, v54
    v_mul_f32 v87, v87, v55
    v_exp_f32 v88, v56
    v_exp_f32 v89, v57
    v_exp_f32 v90, v58
    v_exp_f32 v91, v59
    v_exp_f32 v92, v60
    v_exp_f32 v93, v61
    v_exp_f32 v94, v62
    v_exp_f32 v95, v63
    v_add_f32 v88, 1.0, v88
    v_add_f32 v89, 1.0, v89
    v_add_f32 v90, 1.0, v90
    v_add_f32 v91, 1.0, v91
    v_add_f32 v92, 1.0, v92
    v_add_f32 v93, 1.0, v93
    v_add_f32 v94, 1.0, v94
    v_add_f32 v95, 1.0, v95
    v_rcp_f32 v88, v88
    v_rcp_f32 v89, v89
    v_rcp_f32 v90, v90
    v_rcp_f32 v91, v91
    v_rcp_f32 v92, v92
    v_rcp_f32 v93, v93
    v_rcp_f32 v94, v94
    v_rcp_f32 v95, v95
    v_mul_f32 v88, v88, v56
    v_mul_f32 v89, v89, v57
    v_mul_f32 v90, v90, v58
    v_mul_f32 v91, v91, v59
    v_mul_f32 v92, v92, v60
    v_mul_f32 v93, v93, v61
    v_mul_f32 v94, v94, v62
    v_mul_f32 v95, v95, v63
L_kwaitB:
    ds_read_b32 v177, v27
    ds_read_b128 v[160:163], v25
L_kgoB:
    s_waitcnt lgkmcnt(0)
    v_cmp_eq_u32 vcc, 0, v177
    v_max3_u32 v160, v160, v161, v162
    v_max_u32 v160, v160, v163
    s_cbranch_vccnz L_kwaitB
    v_readfirstlane_b32 s38, v31
    v_readfirstlane_b32 s62, v160
    s_andn2_b32 s63, 0x7ff, s62
    s_bfe_u32 s44, s63, 0x20007
    s_cmp_eq_u32 s44, s45
    s_cbranch_scc0 L_notmineB
    s_mul_i32 s44, s63, 896
    s_add_u32 s44, s44, s58
    v_cmp_eq_u32 s[46:47], s44, v248
    s_nop 1
    v_cndmask_b32 v248, v248, 2.0, s[46:47]
    v_cmp_eq_u32 s[46:47], s44, v249
    s_nop 1
    v_cndmask_b32 v249, v249, 2.0, s[46:47]
    v_cmp_eq_u32 s[46:47], s44, v250
    s_nop 1
    v_cndmask_b32 v250, v250, 2.0, s[46:47]
    v_cmp_eq_u32 s[46:47], s44, v251
    s_nop 1
    v_cndmask_b32 v251, v251, 2.0, s[46:47]
    v_cmp_eq_u32 s[46:47], s44, v216
    s_nop 1
    v_cndmask_b32 v216, v216, 2.0, s[46:47]
    v_cmp_eq_u32 s[46:47], s44, v217
    s_nop 1
    v_cndmask_b32 v217, v217, 2.0, s[46:47]
    v_cmp_eq_u32 s[46:47], s44, v218
    s_nop 1
    v_cndmask_b32 v218, v218, 2.0, s[46:47]
    v_cmp_eq_u32 s[46:47], s44, v219
    s_nop 1
    v_cndmask_b32 v219, v219, 2.0, s[46:47]
L_notmineB:
    s_cmp_eq_u32 s94, 0
    s_cbranch_scc1 L_noprepB
    v_and_b32 v9, 3, v1
    s_mul_i32 s44, s63, 896
    s_lshl_b32 s50, s42, 3
    s_add_u32 s44, s44, s50
    v_lshl_add_u32 v10, v9, 1, s44
    s_lshr_b32 s44, s63, 1
    s_lshl_b32 s44, s44, 2
    s_and_b32 s50, s63, 1
    s_add_u32 s44, s44, s50
    s_lshl_b32 s44, s44, 2
    s_add_u32 s44, s44, 16384
    v_mov_b32 v12, s44
    s_and_b32 s44, s42, 0x60
    s_and_b32 s50, s42, 1
    s_lshl_b32 s50, s50, 4
    s_add_u32 s44, s44, s50
    s_bfe_u32 s50, s42, 0x40001
    s_add_u32 s44, s44, s50
    s_lshl_b32 s44, s44, 4
    s_add_u32 s44, s44, 65536
    v_min_u32 v8, 55, v1
    v_lshl_add_u32 v8, v8, 11, s44
    s_and_b32 s50, s63, 12
    s_bfe_u32 s44, s63, 0x20008
    s_add_u32 s50, s50, s44
    s_lshr_b32 s44, s63, 10
    s_lshl_b32 s44, s44, 4
    s_add_u32 s50, s50, s44
    s_mul_i32 s50, s50, 2064
    s_and_b32 s44, s63, 0xf0
    s_add_u32 s50, s50, s44
    s_and_b32 s44, s63, 3
    s_lshl_b32 s44, s44, 2
    s_add_u32 s50, s50, s44
    s_add_u32 s50, s50, 1024
    v_lshl_add_u32 v14, v9, 8, s50
    s_lshr_b32 s44, s63, 8
    s_lshl_b32 s44, s44, 4
    v_add_u32 v15, s44, v27
    s_ashr_i32 s44, s62, 31
    s_orn2_b32 s44, 0x80000000, s44
    s_xor_b32 s44, s44, s62
    v_cvt_pk_bf16_f32 v16, 0, s44
    v_mul_f32 v16, s60, v16
    v_exp_f32 v16, v16
    s_lshr_b32 s51, s38, 8
    s_lshr_b32 s52, s38, 16
    v_add_f32 v16, 1.0, v16
    v_rcp_f32 v16, v16
    s_lshr_b32 s53, s38, 24
    v_cvt_pk_bf16_f32 v16, 0, v16
L_noprepB:
    s_waitcnt vmcnt(2)
    v_lshlrev_b32 v128, 16, v240
    v_and_b32 v129, s43, v240
    v_lshlrev_b32 v130, 16, v241
    v_and_b32 v131, s43, v241
    v_lshlrev_b32 v132, 16, v242
    v_and_b32 v133, s43, v242
    v_lshlrev_b32 v134, 16, v243
    v_and_b32 v135, s43, v243
    v_and_b32 v170, s43, v208
    v_and_b32 v171, s43, v209
    v_rcp_f32 v170, v170
    v_rcp_f32 v171, v171
    v_lshlrev_b32 v168, 16, v208
    v_lshlrev_b32 v169, 16, v209
    v_mul_f32 v170, s60, v170
    v_mul_f32 v171, s60, v171
    v_mul_f32 v168, v168, v170
    v_mul_f32 v169, v169, v171
    v_fma_f32 v64, v128, v170, -v168
    v_fma_f32 v65, v129, v170, -v168
    v_fma_f32 v66, v130, v170, -v168
    v_fma_f32 v67, v131, v170, -v168
    v_fma_f32 v68, v132, v171, -v169
    v_fma_f32 v69, v133, v171, -v169
    v_fma_f32 v70, v134, v171, -v169
    v_fma_f32 v71, v135, v171, -v169
    v_cvt_pk_bf16_f32 v172, v64, v68
    v_cvt_pk_bf16_f32 v173, v65, v69
    v_cvt_pk_bf16_f32 v174, v66, v70
    v_cvt_pk_bf16_f32 v175, v67, v71
    ds_write_b32 v29, v172 offset:2048
    ds_write_b32 v29, v173 offset:6656
    ds_write_b32 v29, v174 offset:11264
    ds_write_b32 v29, v175 offset:15872
    s_waitcnt vmcnt(0)
    v_lshlrev_b32 v136, 16, v244
    v_and_b32 v137, s43, v244
    v_lshlrev_b32 v138, 16, v245
    v_and_b32 v139, s43, v245
    v_lshlrev_b32 v140, 16, v246
    v_and_b32 v141, s43, v246
    v_lshlrev_b32 v142, 16, v247
    v_and_b32 v143, s43, v247
    v_and_b32 v170, s43, v212
    v_and_b32 v171, s43, v213
    v_rcp_f32 v170, v170
    v_rcp_f32 v171, v171
    v_lshlrev_b32 v168, 16, v212
    v_lshlrev_b32 v169, 16, v213
    v_mul_f32 v170, s60, v170
    v_mul_f32 v171, s60, v171
    v_mul_f32 v168, v168, v170
    v_mul_f32 v169, v169, v171
    v_fma_f32 v72, v136, v170, -v168
    v_fma_f32 v73, v137, v170, -v168
    v_fma_f32 v74, v138, v170, -v168
    v_fma_f32 v75, v139, v170, -v168
    v_fma_f32 v76, v140, v171, -v169
    v_fma_f32 v77, v141, v171, -v169
    v_fma_f32 v78, v142, v171, -v169
    v_fma_f32 v79, v143, v171, -v169
    v_cvt_pk_bf16_f32 v172, v72, v76
    v_cvt_pk_bf16_f32 v173, v73, v77
    v_cvt_pk_bf16_f32 v174, v74, v78
    v_cvt_pk_bf16_f32 v175, v75, v79
    ds_write_b32 v29, v172 offset:3072
    ds_write_b32 v29, v173 offset:7680
    ds_write_b32 v29, v174 offset:12288
    ds_write_b32 v29, v175 offset:16896
    ds_write_b32 v24, v23 offset:16
    ds_read_b32 v177, v28 offset:64
    ds_read_b64 v[160:161], v255 offset:1024
    ds_read_b64 v[162:163], v255 offset:1280
    ds_read_b64 v[164:165], v255 offset:1536
    ds_read_b64 v[166:167], v255 offset:1792
    s_waitcnt lgkmcnt(0)
    v_cmp_eq_u32 vcc, 0, v177
    s_cbranch_vccnz L_ywaitB0
L_yokB0:
    v_fma_f32 v160, v160, v80, v112
    v_fma_f32 v162, v162, v81, v113
    v_fma_f32 v164, v164, v82, v114
    v_fma_f32 v166, v166, v83, v115
    v_cvt_pk_bf16_f32 v178, v160, v162
    v_cvt_pk_bf16_f32 v179, v164, v166
    v_fma_f32 v161, v161, v84, v116
    v_fma_f32 v163, v163, v85, v117
    v_fma_f32 v165, v165, v86, v118
    v_fma_f32 v167, v167, v87, v119
    v_cvt_pk_bf16_f32 v180, v161, v163
    v_cvt_pk_bf16_f32 v181, v165, v167
    buffer_store_dwordx2 v[178:179], v248, s[80:83], 0 offen
    buffer_store_dwordx2 v[180:181], v216, s[80:83], 0 offen
    v_exp_f32 v96, v64
    v_exp_f32 v97, v65
    v_exp_f32 v98, v66
    v_exp_f32 v99, v67
    v_exp_f32 v100, v68
    v_exp_f32 v101, v69
    v_exp_f32 v102, v70
    v_exp_f32 v103, v71
    v_add_f32 v96, 1.0, v96
    v_add_f32 v97, 1.0, v97
    v_add_f32 v98, 1.0, v98
    v_add_f32 v99, 1.0, v99
    v_add_f32 v100, 1.0, v100
    v_add_f32 v101, 1.0, v101
    v_add_f32 v102, 1.0, v102
    v_add_f32 v103, 1.0, v103
    v_rcp_f32 v96, v96
    v_rcp_f32 v97, v97
    v_rcp_f32 v98, v98
    v_rcp_f32 v99, v99
    v_rcp_f32 v100, v100
    v_rcp_f32 v101, v101
    v_rcp_f32 v102, v102
    v_rcp_f32 v103, v103
    v_mul_f32 v96, v96, v64
    v_mul_f32 v97, v97, v65
    v_mul_f32 v98, v98, v66
    v_mul_f32 v99, v99, v67
    v_mul_f32 v100, v100, v68
    v_mul_f32 v101, v101, v69
    v_mul_f32 v102, v102, v70
    v_mul_f32 v103, v103, v71
    ds_read_b32 v177, v28 offset:96
    ds_read_b64 v[160:161], v255 offset:5152
    ds_read_b64 v[162:163], v255 offset:5408
    ds_read_b64 v[164:165], v255 offset:5664
    ds_read_b64 v[166:167], v255 offset:5920
    s_waitcnt lgkmcnt(0)
    v_cmp_eq_u32 vcc, 0, v177
    s_cbranch_vccnz L_ywaitB1
L_yokB1:
    v_fma_f32 v160, v160, v88, v120
    v_fma_f32 v162, v162, v89, v121
    v_fma_f32 v164, v164, v90, v122
    v_fma_f32 v166, v166, v91, v123
    v_cvt_pk_bf16_f32 v182, v160, v162
    v_cvt_pk_bf16_f32 v183, v164, v166
    v_fma_f32 v161, v161, v92, v124
    v_fma_f32 v163, v163, v93, v125
    v_fma_f32 v165, v165, v94, v126
    v_fma_f32 v167, v167, v95, v127
    v_cvt_pk_bf16_f32 v184, v161, v163
    v_cvt_pk_bf16_f32 v185, v165, v167
    buffer_store_dwordx2 v[182:183], v249, s[80:83], 0 offen
    buffer_store_dwordx2 v[184:185], v217, s[80:83], 0 offen
    s_cmp_eq_u32 s94, 0
    s_cbranch_scc1 L_noflB
    global_load_ushort v11, v10, s[4:5]
    global_load_dword v13, v12, s[36:37] sc1
    global_load_dwordx4 v[32:35], v8, s[36:37] sc1
L_noflB:
    ds_read_b32 v177, v28 offset:128
    ds_read_b64 v[160:161], v255 offset:34048
    ds_read_b64 v[162:163], v255 offset:34304
    ds_read_b64 v[164:165], v255 offset:34560
    ds_read_b64 v[166:167], v255 offset:34816
    s_waitcnt lgkmcnt(0)
    v_cmp_eq_u32 vcc, 0, v177
    s_cbranch_vccnz L_ywaitB2
L_yokB2:
    v_fma_f32 v160, v160, v96, v128
    v_fma_f32 v162, v162, v97, v129
    v_fma_f32 v164, v164, v98, v130
    v_fma_f32 v166, v166, v99, v131
    v_cvt_pk_bf16_f32 v178, v160, v162
    v_cvt_pk_bf16_f32 v179, v164, v166
    v_fma_f32 v161, v161, v100, v132
    v_fma_f32 v163, v163, v101, v133
    v_fma_f32 v165, v165, v102, v134
    v_fma_f32 v167, v167, v103, v135
    v_cvt_pk_bf16_f32 v180, v161, v163
    v_cvt_pk_bf16_f32 v181, v165, v167
    buffer_store_dwordx2 v[178:179], v250, s[80:83], 0 offen
    buffer_store_dwordx2 v[180:181], v218, s[80:83], 0 offen
    v_exp_f32 v104, v72
    v_exp_f32 v105, v73
    v_exp_f32 v106, v74
    v_exp_f32 v107, v75
    v_exp_f32 v108, v76
    v_exp_f32 v109, v77
    v_exp_f32 v110, v78
    v_exp_f32 v111, v79
    v_add_f32 v104, 1.0, v104
    v_add_f32 v105, 1.0, v105
    v_add_f32 v106, 1.0, v106
    v_add_f32 v107, 1.0, v107
    v_add_f32 v108, 1.0, v108
    v_add_f32 v109, 1.0, v109
    v_add_f32 v110, 1.0, v110
    v_add_f32 v111, 1.0, v111
    v_rcp_f32 v104, v104
    v_rcp_f32 v105, v105
    v_rcp_f32 v106, v106
    v_rcp_f32 v107, v107
    v_rcp_f32 v108, v108
    v_rcp_f32 v109, v109
    v_rcp_f32 v110, v110
    v_rcp_f32 v111, v111
    v_mul_f32 v104, v104, v72
    v_mul_f32 v105, v105, v73
    v_mul_f32 v106, v106, v74
    v_mul_f32 v107, v107, v75
    v_mul_f32 v108, v108, v76
    v_mul_f32 v109, v109, v77
    v_mul_f32 v110, v110, v78
    v_mul_f32 v111, v111, v79
    s_cmp_eq_u32 s94, 0
    s_cbranch_scc1 L_lastE
    s_mov_b32 s95, 0
    s_mov_b32 s54, 0
    s_mov_b32 s46, 0xaaaaaaaa
    s_mov_b32 s47, 0xaaaaaaaa
    s_mov_b32 s48, 0xcccccccc
    s_mov_b32 s49, 0xcccccccc
    s_mov_b32 s56, -1
    s_mov_b32 s57, 0x00ffffff
    s_waitcnt vmcnt(2)
    v_and_b32 v36, s43, v13
    v_rcp_f32 v36, v36
    v_lshlrev_b32 v46, 16, v11
    v_lshlrev_b32 v37, 16, v13
    v_sub_f32 v37, v46, v37
    v_cvt_pk_bf16_f32 v37, 0, v37
    v_mul_f32 v37, v37, v36
    v_cvt_pk_bf16_f32 v13, 0, v37
L_fin_chk:
    s_add_u32 s54, s54, 1
    v_xor_b32 v36, s38, v32
    v_xor_b32 v37, s51, v33
    v_xor_b32 v38, s52, v34
    v_xor_b32 v39, s53, v35
    v_or3_b32 v36, v36, v37, v38
    v_cndmask_b32 v40, v32, v33, s[46:47]
    v_or_b32 v36, v36, v39
    v_cndmask_b32 v41, v33, v32, s[46:47]
    v_and_b32 v36, 0xff, v36
    v_cndmask_b32 v42, v34, v35, s[46:47]
    v_cmp_ne_u32 vcc, 0, v36
    v_cndmask_b32 v43, v35, v34, s[46:47]
    s_cbranch_vccz L_fin_got
    s_cmp_ge_u32 s54, 131072
    s_cbranch_scc1 L_fin_got
    global_load_dwordx4 v[32:35], v8, s[36:37] sc1
    s_cmp_eq_u32 s95, 1
    s_cbranch_scc1 L_fin_w
    ds_read_b32 v177, v28 offset:160
    s_waitcnt lgkmcnt(0)
    v_cmp_eq_u32 vcc, 0, v177
    s_cbranch_vccz L_lastE
L_fin_w:
    s_waitcnt vmcnt(0)
    s_branch L_fin_chk
L_fin_got:
    v_add_f32_dpp v40, v41, v40 quad_perm:[1,0,3,2] row_mask:0xf bank_mask:0xf
    v_add_f32_dpp v42, v43, v42 quad_perm:[1,0,3,2] row_mask:0xf bank_mask:0xf
    v_cndmask_b32 v41, v42, v40, s[48:49]
    v_cndmask_b32 v40, v40, v42, s[48:49]
    s_nop 1
    v_add_f32_dpp v40, v41, v40 quad_perm:[2,3,0,1] row_mask:0xf bank_mask:0xf
    v_cndmask_b32 v40, 0, v40, s[56:57]
    s_nop 1
    v_add_f32_dpp v40, v40, v40 row_ror:4 row_mask:0xf bank_mask:0xf
    s_nop 1
    v_add_f32_dpp v40, v40, v40 row_ror:8 row_mask:0xf bank_mask:0xf
    v_mov_b32 v41, v40
    s_nop 1
    v_permlane16_swap_b32 v40, v41
    v_add_f32 v40, v40, v41
    v_mov_b32 v41, v40
    s_nop 1
    v_permlane32_swap_b32 v40, v41
    v_add_f32 v40, v40, v41
    v_cvt_pk_bf16_f32 v42, 0, v40
    v_mul_f32 v42, v42, v16
    v_cvt_pk_bf16_f32 v42, 0, v42
    v_add_f32 v42, v42, v13
    v_cvt_pk_bf16_f32 v42, 0, v42
    v_mul_f32 v43, s60, v42
    v_exp_f32 v43, v43
    s_nop 0
    v_add_f32 v43, 1.0, v43
    v_rcp_f32 v43, v43
    s_nop 0
    v_mul_f32 v42, v42, v43
    v_cvt_pk_bf16_f32 v42, 0, v42
    s_cmp_eq_u32 s95, 1
    s_cbranch_scc1 L_fy
    s_mov_b32 s95, 2
L_lastE:
    ds_read_b32 v177, v28 offset:160
    ds_read_b64 v[160:161], v255 offset:38176
    ds_read_b64 v[162:163], v255 offset:38432
    ds_read_b64 v[164:165], v255 offset:38688
    ds_read_b64 v[166:167], v255 offset:38944
    s_waitcnt lgkmcnt(0)
    v_cmp_eq_u32 vcc, 0, v177
    s_cbranch_vccnz L_ywaitB3
L_yokB3:
    v_fma_f32 v160, v160, v104, v136
    v_fma_f32 v162, v162, v105, v137
    v_fma_f32 v164, v164, v106, v138
    v_fma_f32 v166, v166, v107, v139
    v_cvt_pk_bf16_f32 v182, v160, v162
    v_cvt_pk_bf16_f32 v183, v164, v166
    buffer_store_dwordx2 v[182:183], v251, s[80:83], 0 offen
    v_fma_f32 v161, v161, v108, v140
    v_fma_f32 v163, v163, v109, v141
    v_fma_f32 v165, v165, v110, v142
    v_fma_f32 v167, v167, v111, v143
    v_cvt_pk_bf16_f32 v184, v161, v163
    v_cvt_pk_bf16_f32 v185, v165, v167
    buffer_store_dwordx2 v[184:185], v219, s[80:83], 0 offen
    s_cmp_eq_u32 s94, 0
    s_cbranch_scc1 L_nofinal
    s_cmp_eq_u32 s95, 2
    s_cbranch_scc1 L_fy
    s_mov_b32 s95, 1
    s_waitcnt vmcnt(2)
    s_branch L_fin_chk
L_fy:
    ds_read_b32 v44, v15 offset:64
    ds_read_b32 v45, v14
    s_waitcnt lgkmcnt(0)
    v_cmp_eq_u32 vcc, 0, v44
    v_mul_f32 v45, s60, v45
    s_cbranch_vccnz L_fy
    v_cvt_pk_bf16_f32 v45, 0, v45
    v_mul_f32 v43, v42, v45
    v_cvt_pk_bf16_f32 v43, 0, v43
    s_mov_b64 exec, 15
    v_add_f32 v43, v43, v46
    v_cvt_pk_bf16_f32 v43, v43, v43
    global_store_short v10, v43, s[32:33]
    s_mov_b64 exec, -1
L_nofinal:
    s_branch L_exit
L_ywaitB0:
    ds_read_b32 v177, v28 offset:64
    ds_read_b64 v[160:161], v255 offset:1024
    ds_read_b64 v[162:163], v255 offset:1280
    ds_read_b64 v[164:165], v255 offset:1536
    ds_read_b64 v[166:167], v255 offset:1792
    s_waitcnt lgkmcnt(0)
    v_cmp_eq_u32 vcc, 0, v177
    s_cbranch_vccnz L_ywaitB0
    s_branch L_yokB0
L_ywaitB1:
    ds_read_b32 v177, v28 offset:96
    ds_read_b64 v[160:161], v255 offset:5152
    ds_read_b64 v[162:163], v255 offset:5408
    ds_read_b64 v[164:165], v255 offset:5664
    ds_read_b64 v[166:167], v255 offset:5920
    s_waitcnt lgkmcnt(0)
    v_cmp_eq_u32 vcc, 0, v177
    s_cbranch_vccnz L_ywaitB1
    s_branch L_yokB1
L_ywaitB2:
    ds_read_b32 v177, v28 offset:128
    ds_read_b64 v[160:161], v255 offset:34048
    ds_read_b64 v[162:163], v255 offset:34304
    ds_read_b64 v[164:165], v255 offset:34560
    ds_read_b64 v[166:167], v255 offset:34816
    s_waitcnt lgkmcnt(0)
    v_cmp_eq_u32 vcc, 0, v177
    s_cbranch_vccnz L_ywaitB2
    s_branch L_yokB2
L_ywaitB3:
    ds_read_b32 v177, v28 offset:160
    ds_read_b64 v[160:161], v255 offset:38176
    ds_read_b64 v[162:163], v255 offset:38432
    ds_read_b64 v[164:165], v255 offset:38688
    ds_read_b64 v[166:167], v255 offset:38944
    s_waitcnt lgkmcnt(0)
    v_cmp_eq_u32 vcc, 0, v177
    s_cbranch_vccnz L_ywaitB3
    s_branch L_yokB3
L_exit:
    s_endpgm
L_ln_body:
    s_mov_b32 s42, 0x3b124925
    s_lshl_b32 s40, s2, 4
    s_sub_u32 s40, 2047, s40
    v_sub_u32 v52, s40, v1
    s_lshl_b32 s40, s2, 7
    s_add_u32 s40, s40, 16384
    v_lshl_add_u32 v53, v1, 3, s40
    s_and_b32 s44, s2, 7
    s_lshr_b32 s45, s2, 3
    s_mul_i32 s40, s44, 6
    s_add_u32 s40, s40, s45
    s_sub_u32 s40, s40, 10
    s_cmp_eq_u32 s44, 7
    s_cselect_b32 s45, 0, s45
    s_cmp_ge_u32 s45, 10
    s_cselect_b32 s89, 1, 0
    s_mov_b32 s93, 0
    s_lshr_b32 s47, s2, 3
    s_and_b32 s45, s39, 1
    s_lshl1_add_u32 s44, s47, s45
    s_lshl2_add_u32 s45, s47, s39
    s_add_u32 s45, s45, 30
    s_cmp_lt_u32 s39, 6
    s_cselect_b32 s50, s45, s44
    s_min_u32 s44, s50, 62
    s_and_b32 s49, s2, 7
    s_cmp_eq_u32 s49, 7
    s_cbranch_scc1 L_pf7
    s_mul_i32 s47, s44, 10923
    s_lshr_b32 s47, s47, 16
    s_mul_i32 s46, s47, 6
    s_sub_u32 s46, s44, s46
    s_and_b32 s45, s46, 1
    s_lshr_b32 s46, s46, 1
    s_sub_u32 s48, s44, 42
    s_cmp_ge_u32 s44, 42
    s_cselect_b32 s45, 2, s45
    s_cselect_b32 s46, 0, s46
    s_cselect_b32 s44, s48, s47
    s_mul_i32 s49, s49, 3
    s_add_u32 s46, s46, s49
    s_branch L_pfc
L_pf7:
    s_mul_i32 s46, s44, 7282
    s_lshr_b32 s46, s46, 16
    s_mul_i32 s47, s46, 9
    s_sub_u32 s44, s44, s47
    s_add_u32 s46, s46, 21
    s_sub_u32 s45, s44, 7
    s_cmp_lt_u32 s44, 7
    s_cselect_b32 s45, 2, s45
    s_cselect_b32 s44, s44, 3
L_pfc:
    s_lshl_b32 s44, s44, 6
    s_cmp_eq_u32 s45, 1
    s_cselect_b64 s[86:87], s[28:29], s[26:27]
    s_lshl_b32 s47, s46, 7
    s_mul_i32 s46, s46, 57344
    s_movk_i32 s48, 3584
    s_cmp_eq_u32 s45, 2
    s_cselect_b64 s[86:87], s[30:31], s[86:87]
    s_cselect_b32 s47, s46, s47
    s_cselect_b32 s48, 128, s48
    v_add_u32 v62, s44, v1
    v_mul_u32_u24 v62, s48, v62
    v_add_u32 v62, s47, v62
    s_cmp_lt_u32 s39, 6
    s_cbranch_scc1 L_ln_nopf1
    global_load_dword v231, v62, s[86:87]
    s_waitcnt vmcnt(2)
    s_branch L_ln_go
L_ln_nopf1:
    s_waitcnt vmcnt(1)
    s_cmp_lt_u32 s39, 2
    s_cbranch_scc1 L_ln_go
    s_cmp_gt_u32 s50, 62
    s_cbranch_scc1 L_ln_go
    global_load_dword v231, v62, s[86:87]
L_ln_go:
    s_mov_b32 s41, 0x3f803f80
    v_dot2_f32_bf16 v48, v8, s41, 0
    v_dot2_f32_bf16 v49, v8, v8, 0
    v_dot2_f32_bf16 v50, v8, v16, 0
    v_dot2_f32_bf16 v24, v12, s41, 0
    v_dot2_f32_bf16 v25, v12, v12, 0
    v_dot2_f32_bf16 v26, v12, v16, 0
    v_dot2_f32_bf16 v48, v9, s41, v48
    v_dot2_f32_bf16 v49, v9, v9, v49
    v_dot2_f32_bf16 v50, v9, v17, v50
    v_dot2_f32_bf16 v24, v13, s41, v24
    v_dot2_f32_bf16 v25, v13, v13, v25
    v_dot2_f32_bf16 v26, v13, v17, v26
    v_dot2_f32_bf16 v48, v10, s41, v48
    v_dot2_f32_bf16 v49, v10, v10, v49
    v_dot2_f32_bf16 v50, v10, v18, v50
    v_dot2_f32_bf16 v24, v14, s41, v24
    v_dot2_f32_bf16 v25, v14, v14, v25
    v_dot2_f32_bf16 v26, v14, v18, v26
    v_dot2_f32_bf16 v48, v11, s41, v48
    v_dot2_f32_bf16 v49, v11, v11, v49
    v_dot2_f32_bf16 v50, v11, v19, v50
    v_dot2_f32_bf16 v24, v15, s41, v24
    v_dot2_f32_bf16 v25, v15, v15, v25
    v_dot2_f32_bf16 v26, v15, v19, v26
    v_lshrrev_b32 v2, 5, v0
    v_lshlrev_b32 v2, 4, v2
    s_mov_b32 s43, 0xffff0000
    v_permlane32_swap_b32 v48, v24
    v_permlane32_swap_b32 v49, v25
    v_permlane32_swap_b32 v50, v26
    v_add_f32 v48, v48, v24
    v_add_f32 v49, v49, v25
    v_add_f32 v50, v50, v26
    v_add_f32_dpp v48, v48, v48 quad_perm:[1,0,3,2] row_mask:0xf bank_mask:0xf
    v_add_f32_dpp v49, v49, v49 quad_perm:[1,0,3,2] row_mask:0xf bank_mask:0xf
    v_add_f32_dpp v50, v50, v50 quad_perm:[1,0,3,2] row_mask:0xf bank_mask:0xf
    v_add_f32_dpp v48, v48, v48 quad_perm:[2,3,0,1] row_mask:0xf bank_mask:0xf
    v_add_f32_dpp v49, v49, v49 quad_perm:[2,3,0,1] row_mask:0xf bank_mask:0xf
    v_add_f32_dpp v50, v50, v50 quad_perm:[2,3,0,1] row_mask:0xf bank_mask:0xf
    v_add_f32_dpp v48, v48, v48 row_half_mirror row_mask:0xf bank_mask:0xf
    v_add_f32_dpp v49, v49, v49 row_half_mirror row_mask:0xf bank_mask:0xf
    v_add_f32_dpp v50, v50, v50 row_half_mirror row_mask:0xf bank_mask:0xf
    v_add_f32_dpp v48, v48, v48 row_mirror row_mask:0xf bank_mask:0xf
    v_add_f32_dpp v49, v49, v49 row_mirror row_mask:0xf bank_mask:0xf
    v_add_f32_dpp v50, v50, v50 row_mirror row_mask:0xf bank_mask:0xf
    v_add_f32_dpp v48, v48, v48 row_bcast:15 row_mask:0xa bank_mask:0xf
    v_add_f32_dpp v49, v49, v49 row_bcast:15 row_mask:0xa bank_mask:0xf
    v_add_f32_dpp v50, v50, v50 row_bcast:15 row_mask:0xa bank_mask:0xf
    s_mov_b32 exec_lo, 0x10000
    s_mov_b32 exec_hi, 0x10000
    ds_write_b96 v2, v[48:50]
    s_mov_b64 exec, -1
    s_cmp_lg_u32 s39, 0
    s_cbranch_scc1 L_ln_other
    v_dot2_f32_bf16 v51, v16, s41, 0
    v_dot2_f32_bf16 v51, v17, s41, v51
    v_dot2_f32_bf16 v51, v18, s41, v51
    v_dot2_f32_bf16 v51, v19, s41, v51
    s_waitcnt vmcnt(0)
    v_readfirstlane_b32 s38, v45
    s_mul_i32 s38, s38, 1664525
    s_add_u32 s38, s38, 1013904223
    v_add_f32_dpp v51, v51, v51 quad_perm:[1,0,3,2] row_mask:0xf bank_mask:0xf
    s_nop 1
    v_add_f32_dpp v51, v51, v51 quad_perm:[2,3,0,1] row_mask:0xf bank_mask:0xf
    s_nop 1
    v_add_f32_dpp v51, v51, v51 row_half_mirror row_mask:0xf bank_mask:0xf
    s_nop 1
    v_add_f32_dpp v51, v51, v51 row_mirror row_mask:0xf bank_mask:0xf
    s_nop 1
    v_add_f32_dpp v51, v51, v51 row_bcast:15 row_mask:0xa bank_mask:0xf
    s_nop 1
    v_add_f32_dpp v51, v51, v51 row_bcast:31 row_mask:0xc bank_mask:0xf
    v_mov_b32 v55, s38
    s_cmp_lg_u32 s2, 0
    s_cbranch_scc1 L_ln_nobc
    v_not_b32 v54, v55
    s_mov_b64 exec, 1
    global_store_dwordx2 v20, v[54:55], s[34:35] sc1
    s_mov_b64 exec, -1
L_ln_nobc:
    v_readlane_b32 s44, v51, 63
    s_waitcnt lgkmcnt(0)
    s_barrier
    ds_read_b96 v[48:50], v7
    s_waitcnt lgkmcnt(0)
    v_mul_f32 v48, s42, v48
    v_mul_f32 v49, s42, v49
    v_fma_f32 v49, -v48, v48, v49
    v_max_f32 v49, 0, v49
    v_cvt_pk_bf16_f32 v49, 0, v49
    v_add_f32 v49, 0x3727c5ac, v49
    v_cvt_pk_bf16_f32 v49, 0, v49
    v_sqrt_f32 v49, v49
    v_cvt_pk_bf16_f32 v37, 0, v48
    v_cvt_pk_bf16_f32 v56, v48, v49
    v_fma_f32 v50, -v37, s44, v50
    v_and_b32 v38, s43, v56
    v_rcp_f32 v38, v38
    v_mov_b32_dpp v57, v56 quad_perm:[1,0,3,2] row_mask:0xf bank_mask:0xf
    v_mul_f32 v50, v50, v38
    v_ashrrev_i32 v39, 31, v50
    v_or_b32 v39, 0x80000000, v39
    v_xor_b32 v39, v39, v50
    v_and_b32 v39, 0xfffff800, v39
    v_or_b32 v58, v39, v52
    v_bitop3_b32 v59, v56, v57, v55 bitop3:0x96
    s_nop 0
    v_max_u32_dpp v58, v58, v58 quad_perm:[1,0,3,2] row_mask:0xf bank_mask:0xf
    s_nop 1
    v_max_u32_dpp v58, v58, v58 quad_perm:[2,3,0,1] row_mask:0xf bank_mask:0xf
    s_nop 1
    v_max_u32_dpp v58, v58, v58 row_half_mirror row_mask:0xf bank_mask:0xf
    s_nop 1
    v_max_u32_dpp v58, v58, v58 row_mirror row_mask:0xf bank_mask:0xf
    s_mov_b64 exec, 0x5555
    v_xor_b32 v59, v59, v58
    global_store_dwordx4 v53, v[56:59], s[36:37] sc1
    s_mov_b64 exec, -1
    s_cmp_eq_u32 s89, 0
    s_cbranch_scc1 L_exit
    s_barrier
    s_mov_b32 s89, 2
    s_branch L_ffn
L_ln_other:
    s_waitcnt lgkmcnt(0)
    s_barrier
    s_cmp_eq_u32 s89, 0
    s_cbranch_scc1 L_exit
    s_branch L_ffn
L_x7:
    global_load_dword v231, v230, s[84:85]
    s_cmp_ge_u32 s41, 30
    s_cbranch_scc1 L_exit0
    s_add_u32 s40, s41, 26
    s_mov_b32 s89, 0
    s_mov_b32 s93, 0
L_ffn:
    v_mov_b32 v24, 0
    s_cmp_eq_u32 s39, 7
    s_cbranch_scc1 L_ffn_poller
    s_and_b32 s45, s40, 1
    s_mul_i32 s45, s45, 4
    s_cmp_eq_u32 s89, 0
    s_cselect_b32 s45, s45, 0
    s_add_u32 s46, s39, s45
    s_sub_u32 s47, s46, 7
    s_cmp_ge_u32 s46, 7
    s_cselect_b32 s46, s47, s46
    v_and_b32 v2, 3, v1
    v_bfe_u32 v3, v1, 2, 1
    v_bfe_u32 v10, v1, 3, 1
    v_lshrrev_b32 v4, 4, v1
    s_lshl_b32 s44, s46, 6
    s_add_u32 s44, s44, 1
    v_lshl_add_u32 v5, v4, 3, s44
    v_lshl_add_u32 v5, v10, 5, v5
    v_mul_u32_u24 v5, 3584, v5
    s_lshl_b32 s44, s40, 6
    v_lshl_add_u32 v6, v2, 4, s44
    v_add_u32 v5, v5, v6
    v_cmp_eq_u32 s[52:53], 1, v3
    s_waitcnt lgkmcnt(0)
    v_mov_b32 v6, s26
    v_mov_b32 v7, s28
    v_cndmask_b32 v6, v6, v7, s[52:53]
    v_mov_b32 v7, s27
    v_mov_b32 v8, s29
    v_cndmask_b32 v7, v7, v8, s[52:53]
    v_add_co_u32 v6, vcc, v6, v5
    s_nop 1
    v_addc_co_u32 v7, vcc, 0, v7, vcc
    s_cmp_lg_u32 s89, 1
    s_cbranch_scc1 L_ffn_go
    s_barrier
L_ffn_go:
    s_cmp_eq_u32 s93, 1
    s_cbranch_scc1 L_ffn_body
    global_load_dwordx4 v[64:67], v[6:7], off offset:-3584
    global_load_dwordx4 v[68:71], v[6:7], off offset:0
    global_load_dwordx4 v[72:75], v[6:7], off offset:3584
    v_add_co_u32 v6, vcc, 10752, v6
    s_nop 1
    v_addc_co_u32 v7, vcc, 0, v7, vcc
    global_load_dwordx4 v[76:79], v[6:7], off offset:-3584
    global_load_dwordx4 v[80:83], v[6:7], off offset:0
    global_load_dwordx4 v[84:87], v[6:7], off offset:3584
    v_add_co_u32 v6, vcc, 10752, v6
    s_nop 1
    v_addc_co_u32 v7, vcc, 0, v7, vcc
    global_load_dwordx4 v[88:91], v[6:7], off offset:-3584
    global_load_dwordx4 v[92:95], v[6:7], off offset:0
L_ffn_body:
    v_and_b32 v11, 15, v1
    s_lshl_b32 s44, s40, 5
    s_add_u32 s44, s44, 4
    v_lshl_add_u32 v9, v4, 3, s44
    v_mul_u32_u24 v9, 896, v9
    s_lshl_b32 s44, s39, 4
    v_add_u32 v8, s44, v11
    v_min_u32 v8, 55, v8
    v_lshl_add_u32 v9, v8, 4, v9
    s_barrier
    s_cmp_ge_u32 s39, 4
    s_cselect_b32 s88, 1, 0
    s_cmp_eq_u32 s88, 0
    s_cbranch_scc0 L_ffn_no2
    global_load_dwordx4 v[96:99], v9, s[30:31] offset:-3584
    global_load_dwordx4 v[100:103], v9, s[30:31] offset:-2688
    global_load_dwordx4 v[104:107], v9, s[30:31] offset:-1792
    global_load_dwordx4 v[108:111], v9, s[30:31] offset:-896
    global_load_dwordx4 v[112:115], v9, s[30:31] offset:0
    global_load_dwordx4 v[116:119], v9, s[30:31] offset:896
    global_load_dwordx4 v[120:123], v9, s[30:31] offset:1792
    global_load_dwordx4 v[124:127], v9, s[30:31] offset:2688
L_ffn_no2:
    s_mov_b32 s50, 0x05040100
    s_mov_b32 s51, 0x07060302
    s_lshl_b32 s44, s46, 7
    v_lshl_add_u32 v12, v3, 2, v4
    v_lshl_add_u32 v12, v12, 4, s44
    v_mov_b32 v13, 896
    s_lshl_b32 s45, s39, 8
    s_add_u32 s45, s45, 5120
    v_lshl_add_u32 v14, v4, 4, s45
    s_add_u32 s44, s45, 128
    v_mov_b32 v15, s44
    v_cmp_eq_u32 s[52:53], 0, v2
    s_nop 1
    v_cndmask_b32 v16, v13, v12, s[52:53]
    v_cndmask_b32 v20, v15, v14, s[52:53]
    v_cmp_eq_u32 s[52:53], 1, v2
    s_nop 1
    v_cndmask_b32 v17, v13, v12, s[52:53]
    v_cndmask_b32 v21, v15, v14, s[52:53]
    v_cmp_eq_u32 s[52:53], 2, v2
    s_nop 1
    v_cndmask_b32 v18, v13, v12, s[52:53]
    v_cndmask_b32 v22, v15, v14, s[52:53]
    v_cmp_eq_u32 s[52:53], 3, v2
    s_nop 1
    v_cndmask_b32 v19, v13, v12, s[52:53]
    v_cndmask_b32 v23, v15, v14, s[52:53]
    v_lshl_add_u32 v25, v1, 2, s45
    ds_write_b32 v25, v24
    v_lshl_add_u32 v26, v1, 1, s45
    s_lshl_b32 s44, s39, 9
    s_add_u32 s44, s44, 1024
    v_lshl_add_u32 v29, v10, 8, s44
    v_lshl_add_u32 v29, v3, 7, v29
    v_lshl_add_u32 v29, v2, 5, v29
    v_lshrrev_b32 v28, 5, v1
    v_lshl_add_u32 v29, v28, 4, v29
    s_mov_b32 s62, 0
    s_mov_b32 s63, -1
    v_lshlrev_b32 v30, 2, v1
    v_add_u32 v30, 1024, v30
    s_lshl_b32 s44, s40, 11
    s_lshl_b32 s47, s39, 9
    s_add_u32 s44, s44, s47
    s_add_u32 s44, s44, 65536
    v_lshl_add_u32 v31, v11, 4, s44
    v_lshl_add_u32 v31, v28, 8, v31
    v_mov_b32 v33, 0xff
    s_mov_b32 s44, 0xbfb8aa3b
    s_mov_b32 s60, 0xffff
    s_cmp_eq_u32 s39, 3
    s_cselect_b32 s60, 0xff, s60
    s_cmp_eq_u32 s88, 0
    s_cbranch_scc0 L_ffn_p1only
    s_waitcnt vmcnt(14)
    v_perm_b32 v128, v68, v64, s50
    v_perm_b32 v132, v68, v64, s51
    v_perm_b32 v136, v69, v65, s50
    v_perm_b32 v140, v69, v65, s51
    v_perm_b32 v144, v70, v66, s50
    v_perm_b32 v148, v70, v66, s51
    v_perm_b32 v152, v71, v67, s50
    v_perm_b32 v156, v71, v67, s51
    s_waitcnt vmcnt(12)
    v_perm_b32 v129, v76, v72, s50
    v_perm_b32 v133, v76, v72, s51
    v_perm_b32 v137, v77, v73, s50
    v_perm_b32 v141, v77, v73, s51
    v_perm_b32 v145, v78, v74, s50
    v_perm_b32 v149, v78, v74, s51
    v_perm_b32 v153, v79, v75, s50
    v_perm_b32 v157, v79, v75, s51
    s_waitcnt vmcnt(10)
    v_perm_b32 v130, v84, v80, s50
    v_perm_b32 v134, v84, v80, s51
    v_perm_b32 v138, v85, v81, s50
    v_perm_b32 v142, v85, v81, s51
    v_perm_b32 v146, v86, v82, s50
    v_perm_b32 v150, v86, v82, s51
    v_perm_b32 v154, v87, v83, s50
    v_perm_b32 v158, v87, v83, s51
    s_waitcnt vmcnt(8)
    v_perm_b32 v131, v92, v88, s50
    v_perm_b32 v135, v92, v88, s51
    v_perm_b32 v139, v93, v89, s50
    v_perm_b32 v143, v93, v89, s51
    v_perm_b32 v147, v94, v90, s50
    v_perm_b32 v151, v94, v90, s51
    v_perm_b32 v155, v95, v91, s50
    v_perm_b32 v159, v95, v91, s51
    s_waitcnt vmcnt(6)
    v_perm_b32 v160, v100, v96, s50
    v_perm_b32 v164, v100, v96, s51
    v_perm_b32 v168, v101, v97, s50
    v_perm_b32 v172, v101, v97, s51
    v_perm_b32 v176, v102, v98, s50
    v_perm_b32 v180, v102, v98, s51
    v_perm_b32 v184, v103, v99, s50
    v_perm_b32 v188, v103, v99, s51
    s_waitcnt vmcnt(4)
    v_perm_b32 v161, v108, v104, s50
    v_perm_b32 v165, v108, v104, s51
    v_perm_b32 v169, v109, v105, s50
    v_perm_b32 v173, v109, v105, s51
    v_perm_b32 v177, v110, v106, s50
    v_perm_b32 v181, v110, v106, s51
    v_perm_b32 v185, v111, v107, s50
    v_perm_b32 v189, v111, v107, s51
    s_waitcnt vmcnt(2)
    v_perm_b32 v162, v116, v112, s50
    v_perm_b32 v166, v116, v112, s51
    v_perm_b32 v170, v117, v113, s50
    v_perm_b32 v174, v117, v113, s51
    v_perm_b32 v178, v118, v114, s50
    v_perm_b32 v182, v118, v114, s51
    v_perm_b32 v186, v119, v115, s50
    v_perm_b32 v190, v119, v115, s51
    s_waitcnt vmcnt(0)
    v_perm_b32 v163, v124, v120, s50
    v_perm_b32 v167, v124, v120, s51
    v_perm_b32 v171, v125, v121, s50
    v_perm_b32 v175, v125, v121, s51
    v_perm_b32 v179, v126, v122, s50
    v_perm_b32 v183, v126, v122, s51
    v_perm_b32 v187, v127, v123, s50
    v_perm_b32 v191, v127, v123, s51
    s_branch L_ffn_pdone
L_ffn_p1only:
    s_waitcnt vmcnt(6)
    v_perm_b32 v128, v68, v64, s50
    v_perm_b32 v132, v68, v64, s51
    v_perm_b32 v136, v69, v65, s50
    v_perm_b32 v140, v69, v65, s51
    v_perm_b32 v144, v70, v66, s50
    v_perm_b32 v148, v70, v66, s51
    v_perm_b32 v152, v71, v67, s50
    v_perm_b32 v156, v71, v67, s51
    s_waitcnt vmcnt(4)
    v_perm_b32 v129, v76, v72, s50
    v_perm_b32 v133, v76, v72, s51
    v_perm_b32 v137, v77, v73, s50
    v_perm_b32 v141, v77, v73, s51
    v_perm_b32 v145, v78, v74, s50
    v_perm_b32 v149, v78, v74, s51
    v_perm_b32 v153, v79, v75, s50
    v_perm_b32 v157, v79, v75, s51
    s_waitcnt vmcnt(2)
    v_perm_b32 v130, v84, v80, s50
    v_perm_b32 v134, v84, v80, s51
    v_perm_b32 v138, v85, v81, s50
    v_perm_b32 v142, v85, v81, s51
    v_perm_b32 v146, v86, v82, s50
    v_perm_b32 v150, v86, v82, s51
    v_perm_b32 v154, v87, v83, s50
    v_perm_b32 v158, v87, v83, s51
    s_waitcnt vmcnt(0)
    v_perm_b32 v131, v92, v88, s50
    v_perm_b32 v135, v92, v88, s51
    v_perm_b32 v139, v93, v89, s50
    v_perm_b32 v143, v93, v89, s51
    v_perm_b32 v147, v94, v90, s50
    v_perm_b32 v151, v94, v90, s51
    v_perm_b32 v155, v95, v91, s50
    v_perm_b32 v159, v95, v91, s51
L_ffn_pdone:
    s_mov_b64 exec, 0
    s_branch L_fpad1
L_fpadr:
    s_mov_b64 exec, -1
    s_barrier
    ds_read_b128 v[192:195], v16
    ds_read_b128 v[196:199], v17
    ds_read_b128 v[200:203], v18
    ds_read_b128 v[204:207], v19
    s_waitcnt lgkmcnt(3)
    v_mfma_f32_16x16x32_bf16 v[208:211], v[192:195], v[128:131], 0
    v_mfma_f32_16x16x32_bf16 v[212:215], v[192:195], v[144:147], 0
    s_waitcnt lgkmcnt(2)
    v_mfma_f32_16x16x32_bf16 v[208:211], v[196:199], v[132:135], v[208:211]
    v_mfma_f32_16x16x32_bf16 v[212:215], v[196:199], v[148:151], v[212:215]
    s_waitcnt lgkmcnt(1)
    v_mfma_f32_16x16x32_bf16 v[208:211], v[200:203], v[136:139], v[208:211]
    v_mfma_f32_16x16x32_bf16 v[212:215], v[200:203], v[152:155], v[212:215]
    s_waitcnt lgkmcnt(0)
    v_mfma_f32_16x16x32_bf16 v[208:211], v[204:207], v[140:143], v[208:211]
    v_mfma_f32_16x16x32_bf16 v[212:215], v[204:207], v[156:159], v[212:215]
    s_mov_b32 exec_lo, 0xff0000ff
    s_mov_b32 exec_hi, 0xff0000ff
    s_nop 5
    v_cndmask_b32 v208, v208, v212, s[62:63]
    v_cndmask_b32 v209, v209, v213, s[62:63]
    v_cndmask_b32 v210, v210, v214, s[62:63]
    v_cndmask_b32 v211, v211, v215, s[62:63]
    ds_write_b128 v29, v[208:211]
    s_mov_b64 exec, -1
    s_waitcnt lgkmcnt(0)
    s_barrier
    s_cmp_eq_u32 s88, 0
    s_cbranch_scc0 L_exit
L_fpad0:
    s_cbranch_execz L_fpadr
    ds_read_b128 v[80:83], v24 offset:7168
    ds_read2st64_b32 v[64:65], v30 offset0:0 offset1:1
    ds_read2st64_b32 v[66:67], v30 offset0:2 offset1:3
    ds_read2st64_b32 v[68:69], v30 offset0:4 offset1:5
    ds_read2st64_b32 v[70:71], v30 offset0:6 offset1:7
    ds_read2st64_b32 v[72:73], v30 offset0:8 offset1:9
    ds_read2st64_b32 v[74:75], v30 offset0:10 offset1:11
    ds_read2st64_b32 v[76:77], v30 offset0:12 offset1:13
    s_waitcnt lgkmcnt(5)
    v_add_f32 v64, v64, v65
    v_add_f32 v66, v66, v67
    s_waitcnt lgkmcnt(3)
    v_add_f32 v68, v68, v69
    v_add_f32 v70, v70, v71
    v_add_f32 v64, v64, v66
    s_waitcnt lgkmcnt(1)
    v_add_f32 v72, v72, v73
    v_add_f32 v74, v74, v75
    v_add_f32 v68, v68, v70
    s_waitcnt lgkmcnt(0)
    v_add_f32 v76, v76, v77
    v_add_f32 v72, v72, v74
    v_add_f32 v64, v64, v68
    v_add_f32 v72, v72, v76
    v_add_f32 v64, v64, v72
    v_cvt_pk_bf16_f32 v64, 0, v64
    v_mul_f32 v66, s44, v64
    v_mov_b32 v67, v64
    v_exp_f32 v66, v66
    v_mov_b32 v68, v64
    v_add_f32 v66, 1.0, v66
    v_rcp_f32 v66, v66
    v_permlane32_swap_b32 v67, v68
    v_mul_f32 v64, v64, v66
    v_cvt_pk_bf16_f32 v64, 0, v64
    v_mul_f32 v64, v64, v68
    v_cvt_pk_bf16_f32 v64, v64, v64
    ds_write_b16 v26, v64
L_fpad1:
    s_cbranch_execz L_fpad0
    ds_read_b128 v[192:195], v20
    ds_read_b128 v[196:199], v21
    ds_read_b128 v[200:203], v22
    ds_read_b128 v[204:207], v23
    s_waitcnt lgkmcnt(3)
    v_mfma_f32_16x16x32_bf16 v[208:211], v[192:195], v[160:163], 0
    v_mfma_f32_16x16x32_bf16 v[212:215], v[192:195], v[176:179], 0
    s_waitcnt lgkmcnt(2)
    v_mfma_f32_16x16x32_bf16 v[208:211], v[196:199], v[164:167], v[208:211]
    v_mfma_f32_16x16x32_bf16 v[212:215], v[196:199], v[180:183], v[212:215]
    s_waitcnt lgkmcnt(1)
    v_mfma_f32_16x16x32_bf16 v[208:211], v[200:203], v[168:171], v[208:211]
    v_mfma_f32_16x16x32_bf16 v[212:215], v[200:203], v[184:187], v[212:215]
    s_waitcnt lgkmcnt(0)
    v_mfma_f32_16x16x32_bf16 v[208:211], v[204:207], v[172:175], v[208:211]
    v_mfma_f32_16x16x32_bf16 v[212:215], v[204:207], v[188:191], v[212:215]
    s_mov_b32 exec_lo, s60
    s_mov_b32 exec_hi, s60
    s_nop 5
    v_cndmask_b32 v208, v208, v212, s[62:63]
    v_cndmask_b32 v209, v209, v213, s[62:63]
    v_cndmask_b32 v210, v210, v214, s[62:63]
    v_cndmask_b32 v211, v211, v215, s[62:63]
    v_bfi_b32 v208, v33, v80, v208
    v_bfi_b32 v209, v33, v81, v209
    v_bfi_b32 v210, v33, v82, v210
    v_bfi_b32 v211, v33, v83, v211
    global_store_dwordx4 v31, v[208:211], s[36:37] sc1
    s_mov_b64 exec, -1
    s_branch L_exit
L_ffn_poller:
    s_waitcnt lgkmcnt(0)
    s_mov_b32 s43, 0xffff0000
    v_lshlrev_b32 v27, 7, v1
    v_add_u32 v27, 16384, v27
    v_add_u32 v26, 8192, v27
    v_lshlrev_b32 v37, 4, v1
    v_min_u32 v39, 880, v37
    v_mov_b32 v38, v39
    v_mov_b32 v47, 16384
    v_cmp_gt_u32 s[60:61], 56, v1
    s_mov_b32 s54, 0
    s_mov_b32 s55, 0
    s_mov_b64 exec, 0
    s_branch L_ppad1
L_ppadr:
    s_mov_b64 exec, -1
    s_cmp_eq_u32 s89, 0
    s_cbranch_scc1 L_ffn_pure2
    s_barrier
L_ffn_pure2:
    s_barrier
    s_setprio 2
    s_mov_b64 s[46:47], -1
    s_mov_b64 s[48:49], -1
    v_mov_b32 v36, 0
L_ffn_poll:
    s_add_u32 s54, s54, 1
    global_load_dwordx2 v[62:63], v24, s[34:35] sc1
    global_load_dwordx4 v[40:43], v38, s[4:5]
    global_load_dwordx4 v[56:59], v47, s[36:37] sc1
    s_mov_b64 exec, s[46:47]
    s_cbranch_execz L_pl1
    global_load_dwordx4 v[28:31], v27, s[36:37] sc1
L_pl1:
    s_mov_b64 exec, s[48:49]
    s_cbranch_execz L_pl2
    global_load_dwordx4 v[32:35], v26, s[36:37] sc1
L_pl2:
    s_mov_b64 exec, -1
    s_waitcnt vmcnt(0)
    v_xor_b32 v62, v62, v63
    v_bitop3_b32 v60, v28, v29, v31 bitop3:0x96
    v_bitop3_b32 v61, v32, v33, v35 bitop3:0x96
    v_bitop3_b32 v44, v56, v57, v58 bitop3:0x96
    v_xor_b32 v60, v60, v30
    v_xor_b32 v61, v61, v34
    v_xor_b32 v44, v44, v59
    v_cmp_ne_u32 vcc, -1, v62
    v_cmp_ne_u32 s[46:47], v63, v60
    v_cmp_ne_u32 s[48:49], v63, v61
    v_cmp_ne_u32 s[52:53], v63, v44
    s_or_b64 s[46:47], s[46:47], vcc
    s_or_b64 s[48:49], s[48:49], vcc
    v_cndmask_b32 v60, v30, 0, s[46:47]
    v_cndmask_b32 v61, v34, 0, s[48:49]
    s_or_b64 s[50:51], s[46:47], s[48:49]
    v_max_u32 v36, v60, v61
    s_or_b64 s[50:51], s[50:51], s[52:53]
    s_nop 0
    v_max_u32_dpp v36, v36, v36 quad_perm:[1,0,3,2] row_mask:0xf bank_mask:0xf
    s_nop 1
    v_max_u32_dpp v36, v36, v36 quad_perm:[2,3,0,1] row_mask:0xf bank_mask:0xf
    s_nop 1
    v_max_u32_dpp v36, v36, v36 row_half_mirror row_mask:0xf bank_mask:0xf
    s_nop 1
    v_max_u32_dpp v36, v36, v36 row_mirror row_mask:0xf bank_mask:0xf
    s_nop 1
    v_max_u32_dpp v36, v36, v36 row_bcast:15 row_mask:0xa bank_mask:0xf
    s_nop 1
    v_max_u32_dpp v36, v36, v36 row_bcast:31 row_mask:0xc bank_mask:0xf
    s_nop 0
    v_readlane_b32 s56, v36, 63
    s_cmp_eq_u32 s56, s55
    s_cselect_b64 s[50:51], s[50:51], -1
    s_cmp_eq_u64 s[50:51], 0
    s_cbranch_scc1 L_ffn_got
    s_mov_b32 s55, s56
    s_andn2_b32 s56, 0x7ff, s56
    s_mul_i32 s57, s56, 896
    s_lshr_b32 s56, s56, 1
    s_lshl_b32 s56, s56, 4
    s_add_u32 s56, s56, 16384
    v_add_u32 v38, s57, v39
    v_mov_b32 v47, s56
    s_cmp_lt_u32 s54, 131072
    s_cbranch_scc1 L_ffn_poll
L_ffn_got:
L_ppad0:
    s_cbranch_execz L_ppadr
    s_bitcmp0_b32 s55, 0
    s_cselect_b64 s[52:53], -1, 0
    v_cndmask_b32 v56, v56, v57, s[52:53]
    v_and_b32 v44, s43, v56
    v_rcp_f32 v44, v44
    v_lshlrev_b32 v45, 16, v56
    v_lshlrev_b32 v48, 16, v40
    v_and_b32 v49, s43, v40
    v_lshlrev_b32 v50, 16, v41
    v_and_b32 v51, s43, v41
    v_lshlrev_b32 v52, 16, v42
    v_and_b32 v53, s43, v42
    v_lshlrev_b32 v54, 16, v43
    v_and_b32 v55, s43, v43
    v_cndmask_b32 v44, 0, v44, s[60:61]
    v_sub_f32 v48, v48, v45
    v_sub_f32 v49, v49, v45
    v_sub_f32 v50, v50, v45
    v_sub_f32 v51, v51, v45
    v_sub_f32 v52, v52, v45
    v_sub_f32 v53, v53, v45
    v_sub_f32 v54, v54, v45
    v_sub_f32 v55, v55, v45
    v_cvt_pk_bf16_f32 v48, 0, v48
    v_cvt_pk_bf16_f32 v49, 0, v49
    v_cvt_pk_bf16_f32 v50, 0, v50
    v_cvt_pk_bf16_f32 v51, 0, v51
    v_cvt_pk_bf16_f32 v52, 0, v52
    v_cvt_pk_bf16_f32 v53, 0, v53
    v_cvt_pk_bf16_f32 v54, 0, v54
    v_cvt_pk_bf16_f32 v55, 0, v55
    v_mul_f32 v48, v48, v44
    v_mul_f32 v49, v49, v44
    v_mul_f32 v50, v50, v44
    v_mul_f32 v51, v51, v44
    v_mul_f32 v52, v52, v44
    v_mul_f32 v53, v53, v44
    v_mul_f32 v54, v54, v44
    v_mul_f32 v55, v55, v44
L_ppad1:
    s_cbranch_execz L_ppad0
    v_cvt_pk_bf16_f32 v40, v48, v49
    v_cvt_pk_bf16_f32 v41, v50, v51
    v_cvt_pk_bf16_f32 v42, v52, v53
    v_cvt_pk_bf16_f32 v43, v54, v55
    ds_write_b128 v37, v[40:43]
    s_waitcnt lgkmcnt(0)
    s_barrier
    v_mov_b32 v60, v63
    v_lshlrev_b32 v61, 3, v1
    v_lshrrev_b32 v61, v61, v63
    v_lshlrev_b32 v62, 2, v1
    s_mov_b64 exec, 15
    ds_write_b32 v62, v61 offset:7168
    s_mov_b64 exec, -1
    s_waitcnt lgkmcnt(0)
    s_barrier
    s_cmp_lg_u32 s40, 0
    s_cbranch_scc1 L_exit
    s_mov_b64 exec, 1
    global_store_dword v24, v60, s[36:37] sc1
    s_mov_b64 exec, -1
    s_branch L_exit
L_exit0:
    s_endpgm
L_data_end:
.section .rodata,"a"
.p2align 6
.amdhsa_kernel recurrent_scan__ssm_conv_s4__moe_arch_mod__prompt_kernel
  .amdhsa_next_free_vgpr 256
  .amdhsa_next_free_sgpr 96
  .amdhsa_accum_offset 256
  .amdhsa_group_segment_fixed_size 0
  .amdhsa_kernarg_size 136
  .amdhsa_user_sgpr_count 2
  .amdhsa_user_sgpr_kernarg_segment_ptr 1
  .amdhsa_system_sgpr_workgroup_id_x 1
  .amdhsa_ieee_mode 0
.end_amdhsa_kernel
```
